```python
import torch

def _softmax(x, axis=-1):
    return torch.softmax(x, dim=axis)
def _gelu(x):
    return torch.nn.functional.gelu(x, approximate="tanh")
def _silu(x):
    return torch.nn.functional.silu(x)
def _sigmoid(x):
    return torch.sigmoid(x)
def _layernorm(x, axis=-1, eps=1e-5):
    m = x.mean(dim=axis, keepdim=True)
    v = x.var(dim=axis, keepdim=True, unbiased=False)
    return (x - m) / torch.sqrt(v + eps)
def _scatter_add(tgt, idx, src, axis=0):
    return tgt.clone().index_add_(axis, idx, src)
def _segment_sum(src, seg, n):
    out = torch.zeros((n,) + src.shape[1:], dtype=src.dtype)
    return out.index_add_(0, seg, src)
def _pad(x, pw):
    flat = tuple(v for pair in reversed(pw) for v in pair)
    return torch.nn.functional.pad(x, flat)

kernel_name = 'sequential_preLN__ssm_conv_s4d__glu_gated_swiglu__prompt'

def setup_inputs():

    _w = (lambda a: (lambda t: t.to(torch.bfloat16) if t.is_floating_point() else t)(torch.as_tensor(a)))
    def _A_setup():
        Bsz, L, D, N = 1, 2048, 512, 128
        return {
            "u": _w((lambda *s: torch.randn(*s, dtype=torch.bfloat16) * 0.05)(Bsz, L, D)),
            "log_A_real": _w((lambda *s: torch.randn(*s, dtype=torch.bfloat16) * 6.4)(D, N) * 0.5),
            "A_imag": _w((lambda *s: torch.randn(*s, dtype=torch.bfloat16) * 0.05)(D, N) * 3.14),
            "C_real": _w((lambda *s: torch.randn(*s, dtype=torch.bfloat16) * 0.05)(D, N) / N ** 0.5),
            "C_imag": _w((lambda *s: torch.randn(*s, dtype=torch.bfloat16) * 0.05)(D, N) / N ** 0.5),
            "log_dt": _w((lambda *s: torch.randn(*s, dtype=torch.bfloat16) * 0.05)(D) * 0.5 - 4.0),
            "D_skip": _w((lambda *s: torch.randn(*s, dtype=torch.bfloat16) * 0.05)(D)),
        }
    _A_in = _A_setup()

    def _B_setup():
        B, S, D, F = 1, 2048, 512, 1792
        return {
            "x": _w((lambda *s: torch.randn(*s, dtype=torch.bfloat16) * 0.05)(B, S, D)),
            "w1": _w((lambda *s: torch.randn(*s, dtype=torch.bfloat16) * 0.4)(D, F) * (2.0 / D) ** 0.5),
            "w3": _w((lambda *s: torch.randn(*s, dtype=torch.bfloat16) * 0.4)(D, F) * (2.0 / D) ** 0.5),
            "w2": _w((lambda *s: torch.randn(*s, dtype=torch.bfloat16) * 0.4)(F, D) * (2.0 / F) ** 0.5),
        }
    _B_in = _B_setup()

    return {
        "A_u": _A_in["u"],
        "A_log_A_real": _A_in["log_A_real"],
        "A_A_imag": _A_in["A_imag"],
        "A_C_real": _A_in["C_real"],
        "A_C_imag": _A_in["C_imag"],
        "A_log_dt": _A_in["log_dt"],
        "A_D_skip": _A_in["D_skip"],
        "B_x": _B_in["x"],
        "B_w1": _B_in["w1"],
        "B_w3": _B_in["w3"],
        "B_w2": _B_in["w2"],
    }

def reference(A_u, A_log_A_real, A_A_imag, A_C_real, A_C_imag, A_log_dt, A_D_skip, B_x, B_w1, B_w3, B_w2):
    def _A_ref(u, log_A_real, A_imag, C_real, C_imag, log_dt, D_skip):
        L = u.shape[1]
        dt = torch.exp(log_dt)
        A = -torch.exp(log_A_real) + 1j * A_imag
        C = (C_real + 1j * C_imag) * dt[:, None]
        pos = (lambda x, dt: x.to(dt))(torch.arange(L), log_dt.dtype)
        P = torch.exp((A * dt[:, None])[:, :, None] * pos[None, None, :])
        K = 2.0 * torch.einsum("dn,dnl->dl", C, P).real
        L2 = 2 * L
        u_t = (lambda x, *d: x.permute(*d))(u, 0, 2, 1)
        Kf = (lambda x, *a, **k: torch.fft.rfft(x.float(), *a, **k))(K, L2)
        Uf = (lambda x, *a, **k: torch.fft.rfft(x.float(), *a, **k))(u_t, L2)
        y = (lambda x, *a, **k: torch.fft.irfft(x, *a, **k).to(torch.bfloat16))(Uf * Kf[None, :, :], L2)[:, :, :L]
        y = (lambda x, *d: x.permute(*d))(y, 0, 2, 1)
        return y + u * D_skip[None, None, :]

    def _B_ref(x, w1, w3, w2):
        gate = torch.einsum("bsd,df->bsf", x, w1)
        up = torch.einsum("bsd,df->bsf", x, w3)
        h = _silu(gate) * up
        out = torch.einsum("bsf,fd->bsd", h, w2)
        return out

    x = A_u
    h = x + _A_ref(_layernorm(x, axis=-1), A_log_A_real, A_A_imag, A_C_real, A_C_imag, A_log_dt, A_D_skip)
    h2 = h + _B_ref(_layernorm(h, axis=-1), B_w1, B_w3, B_w2)
    return h2
```

```asm
; @launch grid=(256,1,1) block=(512,1,1) lds=162560
.amdgcn_target "amdgcn-amd-amdhsa--gfx950"
.text
.globl sequential_preLN__ssm_conv_s4d__glu_gated_swiglu__prompt_kernel
.p2align 8
.type sequential_preLN__ssm_conv_s4d__glu_gated_swiglu__prompt_kernel,@function
sequential_preLN__ssm_conv_s4d__glu_gated_swiglu__prompt_kernel:
    s_load_dwordx16 s[4:19], s[0:1], 0
    s_load_dwordx4 s[20:23], s[0:1], 64
    s_load_dwordx2 s[24:25], s[0:1], 80
    s_load_dwordx4 s[56:59], s[0:1], 96
    s_lshr_b32 s3, s2, 3
    s_lshl_b32 s3, s3, 11
    v_lshrrev_b32 v96, 5, v0
    v_lshl_add_u32 v96, v96, 7, s3
    v_min_u32 v96, L_code_end-L_ka_pf-4, v96
    s_getpc_b64 s[64:65]
L_ka_pf:
    s_add_u32 s64, s64, L_ka_pf-L_ka_pf
    s_addc_u32 s65, s65, 0
    v_mov_b32 v99, s65
    v_add_co_u32 v98, vcc, s64, v96
    s_nop 1
    v_addc_co_u32 v99, vcc, 0, v99, vcc
    s_cmp_ge_u32 s2, 256
    s_cbranch_scc1 L_ka_end
    global_load_dword v97, v[98:99], off
    v_xor_b32 v0, 256, v0
    v_lshrrev_b32 v1, 6, v0
    s_and_b32 s27, s2, 7
    v_readfirstlane_b32 s26, v1
    v_and_b32 v1, 63, v0
    s_lshl_b32 s27, s27, 5
    s_lshr_b32 s28, s2, 3
    s_add_u32 s27, s27, s28
    s_cmp_ge_u32 s26, 4
    s_cbranch_scc1 L_ka_ln0
    s_setprio 1
    s_lshl_b32 s28, s27, 9
    v_lshl_add_u32 v6, v0, 1, s28
    s_lshl_b32 s28, s27, 2
    v_lshrrev_b32 v7, 7, v0
    v_lshl_add_u32 v7, v7, 1, s28
    v_and_b32 v8, 127, v0
    v_lshlrev_b32 v8, 4, v8
    s_getpc_b64 s[64:65]
L_ka_pc0:
    s_add_u32 s64, s64, L_ridx-L_ka_pc0
    s_addc_u32 s65, s65, 0
    v_mov_b32 v11, s65
    v_add_co_u32 v10, vcc, s64, v8
    s_nop 1
    v_addc_co_u32 v11, vcc, 0, v11, vcc
    s_waitcnt lgkmcnt(0)
    global_load_ushort v2, v6, s[6:7] nt
    global_load_ushort v3, v6, s[8:9] nt
    global_load_ushort v4, v6, s[10:11] nt
    global_load_ushort v5, v6, s[12:13] nt
    global_load_ushort v6, v7, s[14:15]
    global_load_dwordx4 v[140:143], v[10:11], off
    global_load_dwordx4 v[144:147], v[10:11], off offset:16
    v_lshlrev_b32 v8, 4, v1
    s_getpc_b64 s[64:65]
L_ka_pc2:
    s_add_u32 s64, s64, L_band-L_ka_pc2
    s_addc_u32 s65, s65, 0
    v_mov_b32 v13, s65
    v_add_co_u32 v12, vcc, s64, v8
    s_nop 1
    v_addc_co_u32 v13, vcc, 0, v13, vcc
    global_load_dwordx4 v[152:155], v[12:13], off offset:0
    global_load_dwordx4 v[156:159], v[12:13], off offset:1024
    global_load_dwordx4 v[160:163], v[12:13], off offset:2048
    global_load_dwordx4 v[164:167], v[12:13], off offset:3072
    v_mov_b32 v78, 0
    s_branch L_ka_common
L_ka_ln0:
    s_setprio 2
    s_sub_u32 s39, s26, 4
    v_and_b32 v62, 255, v0
    s_lshl_b32 s3, s2, 13
    s_lshl_b32 s28, s39, 11
    s_add_u32 s28, s28, s3
    v_lshl_add_u32 v3, v1, 4, s28
    v_lshl_add_u32 v4, v62, 2, s3
    v_add_u32 v5, 4096, v4
    s_and_b32 s28, s2, 15
    s_mul_i32 s28, s28, 256
    s_add_u32 s28, s28, 25231360
    v_mul_u32_u24 v78, 4096, v1
    v_add_u32 v78, s28, v78
    v_mov_b32 v80, 0
    v_mov_b32 v81, 0x5ec7a11d
    s_mul_i32 s28, s39, 65536
    v_add_u32 v79, s28, v78
    s_cmp_ge_u32 s2, 16
    s_waitcnt lgkmcnt(0)
    s_cbranch_scc1 L_ka_nolead
    s_mov_b32 exec_lo, 0xff
    s_mov_b32 exec_hi, 0
    global_store_dwordx2 v79, v[80:81], s[58:59] sc1
    s_mov_b64 exec, -1
L_ka_nolead:
    global_load_dword v16, v4, s[4:5] offset:0 nt
    global_load_dword v17, v4, s[4:5] offset:1024 nt
    global_load_dword v18, v4, s[4:5] offset:2048 nt
    global_load_dword v19, v4, s[4:5] offset:3072 nt
    global_load_dword v20, v5, s[4:5] offset:0 nt
    global_load_dword v21, v5, s[4:5] offset:1024 nt
    global_load_dword v22, v5, s[4:5] offset:2048 nt
    global_load_dword v23, v5, s[4:5] offset:3072 nt
    global_load_dwordx4 v[8:11], v3, s[4:5] nt
    global_load_dwordx4 v[12:15], v3, s[4:5] offset:1024 nt
    v_and_b32 v82, 3, v1
    v_or_b32 v83, 0x0c0c0c00, v82
    s_mov_b32 s28, 0x7800ff01
    v_perm_b32 v83, v83, s28, v83
    v_lshlrev_b32 v82, 21, v82
    v_lshl_add_u32 v82, v83, 13, v82
    global_load_dword v83, v82, s[58:59]
    v_mov_b32 v84, 25227264
    global_load_dword v84, v84, s[58:59]
L_ka_common:
    s_mov_b32 s36, 0xffff0000
    s_bfe_u32 s60, s26, 0x10001
    s_and_b32 s61, s26, 1
    s_lshr_b32 s62, s26, 2
    s_lshl_b32 s62, s62, 1
    s_add_u32 s62, s62, s61
    v_mov_b32 v252, 154112
    s_lshl_b32 s28, s60, 4
    s_add_u32 s28, s28, 154128
    v_mov_b32 v253, s28
    v_mov_b32 v254, 1
    s_mov_b32 s44, 0
    v_mov_b32 v247, 0
    v_lshl_add_u32 v246, v1, 2, v252
    v_min_u32 v246, 154300, v246
    ds_write_b32 v246, v247
    v_mov_b32 v246, 65536
    ds_write_b32 v246, v247
    ds_write_b32 v246, v247 offset:1536
    v_and_b32 v244, 15, v1
    v_lshrrev_b32 v245, 4, v1
    s_waitcnt lgkmcnt(0)
    s_barrier
    s_cmp_ge_u32 s26, 4
    s_cbranch_scc1 L_ka_ln
    s_lshr_b32 s46, s2, 3
    s_lshl_b32 s46, s46, 2
    s_add_u32 s46, s46, s26
    s_and_b32 s49, s46, 1
    s_cselect_b32 s32, s22, s20
    s_cselect_b32 s33, s23, s21
    s_mov_b32 s35, 0x20000
    s_bfe_u32 s48, s46, 0x30001
    s_and_b32 s47, s2, 3
    s_mul_i32 s47, s47, 7
    s_lshr_b32 s50, s46, 4
    s_add_u32 s47, s47, s50
    s_xor_b32 s49, s49, 1
    s_bitcmp1_b32 s2, 2
    s_cselect_b32 s32, s24, s32
    s_cselect_b32 s33, s25, s33
    s_cselect_b32 s45, 2, 1
    s_cselect_b32 s50, s49, 0
    s_cselect_b32 s51, s47, s48
    s_cselect_b32 s52, s48, s47
    s_movk_i32 s55, 3584
    s_cselect_b32 s55, 1024, s55
    s_cmp_ge_u32 s46, 112
    s_cselect_b32 s50, 1, s50
    s_cmp_lg_u32 s50, 0
    s_cselect_b32 s45, 0, s45
    s_cselect_b32 s34, 0, 1835008
    s_mul_i32 s49, s51, s55
    s_lshl_b32 s49, s49, 6
    s_lshl_b32 s50, s52, 7
    s_add_u32 s49, s49, s50
    v_bfe_u32 v220, v1, 3, 1
    v_lshrrev_b32 v221, 4, v1
    v_lshl_add_u32 v220, v220, 2, v221
    s_lshl_b32 s50, s55, 3
    v_mul_u32_u24 v220, s50, v220
    v_and_b32 v221, 7, v1
    v_lshl_add_u32 v220, v221, 4, v220
    s_and_b32 s28, s2, 4
    s_cbranch_scc0 L_aux_n3
    s_and_b32 s28, s46, 1
    s_cbranch_scc1 L_aux_n3
    s_cmp_ge_u32 s46, 80
    s_cbranch_scc1 L_aux_n3
    s_mov_b32 s45, 3
    s_bitcmp1_b32 s46, 2
    s_cselect_b32 s32, s22, s20
    s_cselect_b32 s33, s23, s21
    s_cselect_b32 s51, 14336, 0
    s_mov_b32 s34, 1835008
    s_mov_b32 s55, 14336
    s_and_b32 s47, s2, 3
    s_lshl_b32 s47, s47, 2
    s_bfe_u32 s28, s46, 0x10001
    s_add_u32 s47, s47, s28
    s_add_u32 s47, s47, 1
    s_lshr_b32 s48, s46, 3
    s_mul_i32 s49, s48, 114688
    s_mul_i32 s28, s47, 224
    s_add_u32 s49, s49, s28
    s_add_u32 s49, s49, 688128
    s_mul_i32 s28, s47, 143360
    s_add_u32 s51, s51, s28
    s_lshr_b32 s28, s48, 1
    s_mul_i32 s28, s28, 28672
    s_add_u32 s51, s51, s28
    s_and_b32 s28, s48, 1
    s_mul_i32 s28, s28, 7168
    s_add_u32 s51, s51, s28
    s_add_u32 s51, s51, 7343616
    v_min_u32 v221, 55, v1
    v_mul_u32_u24 v220, 4682, v221
    v_lshrrev_b32 v220, 16, v220
    v_mul_u32_u24 v220, 3360, v220
    v_lshl_add_u32 v220, v221, 4, v220
L_aux_n3:
    v_bfe_u32 v90, v0, 1, 2
    v_bfe_u32 v91, v0, 3, 1
    v_lshlrev_b32 v91, 1, v91
    v_xor_b32 v90, v90, v91
    v_and_b32 v91, 127, v0
    s_lshl_b32 s53, s60, 15
    v_lshl_add_u32 v114, v91, 4, s53
    v_lshlrev_b32 v91, 6, v91
    v_lshl_add_u32 v91, v90, 4, v91
    v_add_u32 v110, s53, v91
    v_xor_b32 v111, 16, v110
    v_xor_b32 v112, 32, v110
    v_xor_b32 v113, 48, v110
    v_bfe_u32 v91, v1, 2, 2
    v_lshl_add_u32 v91, v245, 3, v91
    v_lshlrev_b32 v91, 6, v91
    v_bfe_u32 v92, v1, 1, 1
    v_bfe_u32 v93, v1, 3, 2
    v_xor_b32 v92, v92, v93
    v_lshl_add_u32 v91, v92, 4, v91
    v_and_b32 v92, 1, v1
    v_lshl_add_u32 v91, v92, 3, v91
    v_add_u32 v100, s53, v91
    v_xor_b32 v101, 32, v100
    s_lshl_b32 s54, s61, 5
    v_xor_b32 v104, s54, v100
    v_xor_b32 v105, 32, v104
    s_lshl_b32 s54, s61, 4
    v_add_u32 v91, s54, v244
    v_or_b32 v93, 0x0c0c0c00, v245
    s_mul_i32 s53, s60, 1536
    s_add_u32 s53, s53, 65552
    s_mov_b32 s54, 0x1020303
    v_perm_b32 v94, v94, s54, v93
    v_lshlrev_b32 v95, v94, v91
    s_mov_b32 s54, 0x60400100
    v_perm_b32 v94, v94, s54, v93
    v_lshl_add_u32 v95, v94, 2, v95
    v_lshl_add_u32 v116, v95, 1, s53
    v_add_u32 v117, 2, v116
    s_mov_b32 s54, 0x40020202
    v_perm_b32 v94, v94, s54, v93
    v_lshl_add_u32 v118, v94, 1, v116
    s_mov_b32 s54, 0x41030303
    v_perm_b32 v94, v94, s54, v93
    v_lshl_add_u32 v119, v94, 1, v116
    v_mov_b32 v95, v91
    s_mov_b32 s54, 0xaaaaa080
    v_perm_b32 v94, v94, s54, v93
    v_lshl_add_u32 v95, v94, 2, v95
    v_lshl_add_u32 v120, v95, 1, s53
    s_mov_b32 s54, 0x2820
    v_perm_b32 v94, v94, s54, v93
    v_lshl_add_u32 v121, v94, 1, v120
    s_mov_b32 s54, 0x2840
    v_perm_b32 v94, v94, s54, v93
    v_lshl_add_u32 v122, v94, 1, v120
    s_mov_b32 s54, 0x2860
    v_perm_b32 v94, v94, s54, v93
    v_lshl_add_u32 v123, v94, 1, v120
    s_lshl_b32 s28, s27, 2
    s_load_dword s41, s[16:17], s28
    v_lshl_add_u32 v249, v244, 1, v245
    v_add_u32 v246, 2719, v249
    v_bfe_u32 v247, v246, 3, 1
    v_xor_b32 v247, s60, v247
    v_lshlrev_b32 v246, 5, v246
    v_lshl_add_u32 v224, v247, 4, v246
    v_add_u32 v246, 2715, v249
    v_bfe_u32 v247, v246, 3, 1
    v_xor_b32 v247, s60, v247
    v_lshlrev_b32 v246, 5, v246
    v_lshl_add_u32 v225, v247, 4, v246
    v_add_u32 v246, 2711, v249
    v_bfe_u32 v247, v246, 3, 1
    v_xor_b32 v247, s60, v247
    v_lshlrev_b32 v246, 5, v246
    v_lshl_add_u32 v226, v247, 4, v246
    v_add_u32 v246, 2707, v249
    v_bfe_u32 v247, v246, 3, 1
    v_xor_b32 v247, s60, v247
    v_lshlrev_b32 v246, 5, v246
    v_lshl_add_u32 v227, v247, 4, v246
    s_lshl_b32 s28, s60, 15
    v_lshl_add_u32 v247, v245, 4, s28
    v_and_b32 v246, 7, v244
    v_mul_u32_u24 v246, 2112, v246
    v_lshrrev_b32 v248, 3, v244
    v_sub_u32 v248, 1, v248
    v_lshl_add_u32 v246, v248, 4, v246
    v_add_u32 v228, v246, v247
    v_and_b32 v246, 1, v244
    v_mul_u32_u24 v246, 8448, v246
    v_lshrrev_b32 v248, 1, v244
    v_sub_u32 v248, 7, v248
    v_lshl_add_u32 v246, v248, 4, v246
    v_add_u32 v229, v246, v247
    v_and_b32 v246, 3, v244
    v_mul_u32_u24 v246, 4224, v246
    v_lshrrev_b32 v248, 2, v244
    v_sub_u32 v248, 3, v248
    v_lshl_add_u32 v246, v248, 4, v246
    v_add_u32 v230, v246, v247
    v_bfe_u32 v246, v1, 2, 2
    v_lshl_add_u32 v246, v245, 3, v246
    v_bfe_u32 v247, v1, 2, 1
    v_and_b32 v248, 3, v1
    s_mul_i32 s28, s60, 10752
    s_add_u32 s28, s28, 96520
    v_lshl_add_u32 v248, v248, 3, s28
    v_mul_u32_u24 v249, 3200, v247
    v_lshl_add_u32 v249, v246, 3, v249
    v_add_u32 v231, v248, v249
    v_mul_u32_u24 v249, 2096, v247
    v_lshl_add_u32 v249, v246, 4, v249
    v_add_u32 v232, v248, v249
    v_and_b32 v247, 1, v245
    v_lshrrev_b32 v248, 1, v245
    v_lshl_add_u32 v246, v244, 1, v248
    v_lshl_add_u32 v249, v247, 5, v246
    s_add_u32 s28, s28, 24
    v_lshl_add_u32 v233, v249, 4, s28
    v_bfe_u32 v249, v244, 2, 1
    v_xor_b32 v249, s60, v249
    v_lshl_add_u32 v249, v246, 1, v249
    v_lshl_add_u32 v249, v249, 1, v247
    s_lshl_b32 s28, s62, 11
    s_add_u32 s28, s28, 88064
    v_lshl_add_u32 v234, v249, 3, s28
    s_and_b32 s30, s27, 2
    v_and_b32 v246, 3, v246
    v_xor_b32 v246, s30, v246
    s_lshl_b32 s28, s27, 7
    s_lshl_b32 s30, s60, 6
    s_add_u32 s28, s28, s30
    s_mul_i32 s30, s62, 528384
    s_add_u32 s28, s28, s30
    s_add_u32 s28, s28, 4718592
    v_lshl_add_u32 v246, v246, 4, s28
    v_lshrrev_b32 v249, 1, v244
    v_lshl_add_u32 v249, v247, 3, v249
    s_mov_b32 s30, 33024
    v_mad_u32_u24 v235, v249, s30, v246
    s_waitcnt lgkmcnt(0)
    s_lshl_b32 s42, s41, 16
    s_and_b32 s41, s41, s36
    s_cmp_eq_u32 s60, 0
    s_cselect_b32 s42, s42, s41
    s_and_b32 s14, s2, 3
    s_lshl_b32 s14, s14, 2
    s_lshr_b32 s28, s2, 6
    s_add_u32 s14, s14, s28
    s_mul_i32 s17, s14, 224
    s_mul_i32 s19, s60, 14352
    s_mul_i32 s28, s61, 7168
    s_add_u32 s19, s19, s28
    s_cmp_eq_u32 s60, 0
    s_cselect_b32 s8, s20, s22
    s_cselect_b32 s9, s21, s23
    s_mov_b32 s10, 1835008
    s_mov_b32 s11, 0x20000
    s_mul_i32 s28, s61, 448
    v_add_u32 v90, s28, v1
    v_mul_u32_u24 v91, 4682, v90
    v_lshrrev_b32 v91, 16, v91
    v_mul_u32_u24 v91, 3360, v91
    v_lshl_add_u32 v212, v90, 4, v91
    v_add_u32 v90, 64, v90
    v_mul_u32_u24 v91, 4682, v90
    v_lshrrev_b32 v91, 16, v91
    v_mul_u32_u24 v91, 3360, v91
    v_lshl_add_u32 v213, v90, 4, v91
    v_subrev_u32 v213, 1024, v213
    v_add_u32 v90, 64, v90
    v_mul_u32_u24 v91, 4682, v90
    v_lshrrev_b32 v91, 16, v91
    v_mul_u32_u24 v91, 3360, v91
    v_lshl_add_u32 v214, v90, 4, v91
    v_subrev_u32 v214, 2048, v214
    v_add_u32 v90, 64, v90
    v_mul_u32_u24 v91, 4682, v90
    v_lshrrev_b32 v91, 16, v91
    v_mul_u32_u24 v91, 3360, v91
    v_lshl_add_u32 v215, v90, 4, v91
    v_subrev_u32 v215, 3072, v215
    v_add_u32 v90, 64, v90
    v_mul_u32_u24 v91, 4682, v90
    v_lshrrev_b32 v91, 16, v91
    v_mul_u32_u24 v91, 3360, v91
    v_lshl_add_u32 v216, v90, 4, v91
    v_add_u32 v90, 64, v90
    v_mul_u32_u24 v91, 4682, v90
    v_lshrrev_b32 v91, 16, v91
    v_mul_u32_u24 v91, 3360, v91
    v_lshl_add_u32 v217, v90, 4, v91
    v_subrev_u32 v217, 1024, v217
    v_add_u32 v90, 64, v90
    v_mul_u32_u24 v91, 4682, v90
    v_lshrrev_b32 v91, 16, v91
    v_mul_u32_u24 v91, 3360, v91
    v_lshl_add_u32 v218, v90, 4, v91
    v_subrev_u32 v218, 2048, v218
    s_mov_b32 s43, 0x3fb8aa3b
    s_waitcnt vmcnt(0)
    buffer_load_dwordx4 v[168:171], v220, s[32:35], s49 offen
    s_add_u32 s49, s49, s55
    v_lshlrev_b32 v2, 16, v2
    v_lshlrev_b32 v6, 16, v6
    v_lshlrev_b32 v3, 16, v3
    v_lshlrev_b32 v4, 16, v4
    v_lshlrev_b32 v5, 16, v5
    v_mul_f32 v2, s43, v2
    v_mul_f32 v6, s43, v6
    v_exp_f32 v2, v2
    v_exp_f32 v6, v6
    s_nop 0
    v_cvt_pk_bf16_f32 v2, v2, v6
    v_and_b32 v6, s36, v2
    v_lshlrev_b32 v2, 16, v2
    v_mul_f32 v2, v2, v6
    v_mul_f32 v3, v3, v6
    v_mul_f32 v2, -v2, s43
    v_mul_f32 v3, 0x3e22f983, v3
    v_add_f32 v6, v6, v6
    v_mul_f32 v20, v4, v6
    v_mul_f32 v21, v5, v6
    v_mul_f32 v16, 8.0, v2
    v_mul_f32 v17, 8.0, v3
    v_exp_f32 v16, v16
    v_fract_f32 v17, v17
    v_cos_f32 v10, v17
    v_sin_f32 v11, v17
    s_nop 0
    v_pk_mul_f32 v[10:11], v[10:11], v[16:17] op_sel:[0,0] op_sel_hi:[1,0]
    v_exp_f32 v16, v2
    v_fract_f32 v17, v3
    v_cos_f32 v8, v17
    v_sin_f32 v9, v17
    s_nop 0
    v_pk_mul_f32 v[8:9], v[8:9], v[16:17] op_sel:[0,0] op_sel_hi:[1,0]
    v_mul_f32 v16, 256.0, v2
    v_mul_f32 v17, 256.0, v3
    v_exp_f32 v16, v16
    v_fract_f32 v17, v17
    v_cos_f32 v12, v17
    v_sin_f32 v13, v17
    s_nop 0
    v_pk_mul_f32 v[12:13], v[12:13], v[16:17] op_sel:[0,0] op_sel_hi:[1,0]
    v_pk_mul_f32 v[16:17], v[10:11], v[10:11] op_sel:[0,0] op_sel_hi:[1,0]
    v_pk_fma_f32 v[14:15], v[10:11], v[10:11], v[16:17] op_sel:[1,1,0] op_sel_hi:[0,1,1] neg_lo:[1,0,0]
    v_pk_mul_f32 v[70:71], v[20:21], v[8:9] op_sel:[0,0] op_sel_hi:[1,0]
    v_pk_fma_f32 v[22:23], v[20:21], v[8:9], v[70:71] op_sel:[1,1,0] op_sel_hi:[0,1,1] neg_lo:[1,0,0]
    v_cvt_pk_bf16_f32 v124, v20, v22
    v_cvt_pk_bf16_f32 v128, -v21, -v23
    v_cvt_pk_bf16_f32 v72, 1.0, v10
    v_cvt_pk_bf16_f32 v76, 0, v11
    v_pk_mul_f32 v[68:69], v[10:11], v[14:15] op_sel:[0,0] op_sel_hi:[1,0]
    v_pk_fma_f32 v[10:11], v[10:11], v[14:15], v[68:69] op_sel:[1,1,0] op_sel_hi:[0,1,1] neg_lo:[1,0,0]
    v_pk_mul_f32 v[70:71], v[22:23], v[8:9] op_sel:[0,0] op_sel_hi:[1,0]
    v_pk_fma_f32 v[24:25], v[22:23], v[8:9], v[70:71] op_sel:[1,1,0] op_sel_hi:[0,1,1] neg_lo:[1,0,0]
    v_cvt_pk_bf16_f32 v73, v14, v10
    v_cvt_pk_bf16_f32 v77, v15, v11
    v_pk_mul_f32 v[66:67], v[14:15], v[14:15] op_sel:[0,0] op_sel_hi:[1,0]
    v_pk_mul_f32 v[68:69], v[10:11], v[14:15] op_sel:[0,0] op_sel_hi:[1,0]
    v_pk_fma_f32 v[62:63], v[14:15], v[14:15], v[66:67] op_sel:[1,1,0] op_sel_hi:[0,1,1] neg_lo:[1,0,0]
    v_pk_fma_f32 v[10:11], v[10:11], v[14:15], v[68:69] op_sel:[1,1,0] op_sel_hi:[0,1,1] neg_lo:[1,0,0]
    v_pk_mul_f32 v[70:71], v[24:25], v[8:9] op_sel:[0,0] op_sel_hi:[1,0]
    v_pk_fma_f32 v[26:27], v[24:25], v[8:9], v[70:71] op_sel:[1,1,0] op_sel_hi:[0,1,1] neg_lo:[1,0,0]
    v_cvt_pk_bf16_f32 v125, v24, v26
    v_cvt_pk_bf16_f32 v129, -v25, -v27
    v_cvt_pk_bf16_f32 v74, v62, v10
    v_cvt_pk_bf16_f32 v78, v63, v11
    v_pk_mul_f32 v[66:67], v[62:63], v[14:15] op_sel:[0,0] op_sel_hi:[1,0]
    v_pk_mul_f32 v[68:69], v[10:11], v[14:15] op_sel:[0,0] op_sel_hi:[1,0]
    v_pk_fma_f32 v[62:63], v[62:63], v[14:15], v[66:67] op_sel:[1,1,0] op_sel_hi:[0,1,1] neg_lo:[1,0,0]
    v_pk_fma_f32 v[10:11], v[10:11], v[14:15], v[68:69] op_sel:[1,1,0] op_sel_hi:[0,1,1] neg_lo:[1,0,0]
    buffer_load_dwordx4 v[172:175], v220, s[32:35], s49 offen
    s_add_u32 s49, s49, s55
    v_pk_mul_f32 v[70:71], v[26:27], v[8:9] op_sel:[0,0] op_sel_hi:[1,0]
    v_pk_fma_f32 v[28:29], v[26:27], v[8:9], v[70:71] op_sel:[1,1,0] op_sel_hi:[0,1,1] neg_lo:[1,0,0]
    v_cvt_pk_bf16_f32 v75, v62, v10
    v_cvt_pk_bf16_f32 v79, v63, v11
    v_pk_mul_f32 v[66:67], v[62:63], v[14:15] op_sel:[0,0] op_sel_hi:[1,0]
    v_pk_mul_f32 v[68:69], v[10:11], v[14:15] op_sel:[0,0] op_sel_hi:[1,0]
    v_pk_fma_f32 v[62:63], v[62:63], v[14:15], v[66:67] op_sel:[1,1,0] op_sel_hi:[0,1,1] neg_lo:[1,0,0]
    v_pk_fma_f32 v[10:11], v[10:11], v[14:15], v[68:69] op_sel:[1,1,0] op_sel_hi:[0,1,1] neg_lo:[1,0,0]
    ds_write_b128 v110, v[72:75]
    ds_write_b128 v110, v[76:79] offset:8192
    v_pk_mul_f32 v[70:71], v[28:29], v[8:9] op_sel:[0,0] op_sel_hi:[1,0]
    v_pk_fma_f32 v[30:31], v[28:29], v[8:9], v[70:71] op_sel:[1,1,0] op_sel_hi:[0,1,1] neg_lo:[1,0,0]
    v_cvt_pk_bf16_f32 v126, v28, v30
    v_cvt_pk_bf16_f32 v130, -v29, -v31
    v_pk_mul_f32 v[70:71], v[30:31], v[8:9] op_sel:[0,0] op_sel_hi:[1,0]
    v_pk_fma_f32 v[32:33], v[30:31], v[8:9], v[70:71] op_sel:[1,1,0] op_sel_hi:[0,1,1] neg_lo:[1,0,0]
    v_cvt_pk_bf16_f32 v80, v62, v10
    v_cvt_pk_bf16_f32 v84, v63, v11
    v_pk_mul_f32 v[66:67], v[62:63], v[14:15] op_sel:[0,0] op_sel_hi:[1,0]
    v_pk_mul_f32 v[68:69], v[10:11], v[14:15] op_sel:[0,0] op_sel_hi:[1,0]
    v_pk_fma_f32 v[62:63], v[62:63], v[14:15], v[66:67] op_sel:[1,1,0] op_sel_hi:[0,1,1] neg_lo:[1,0,0]
    v_pk_fma_f32 v[10:11], v[10:11], v[14:15], v[68:69] op_sel:[1,1,0] op_sel_hi:[0,1,1] neg_lo:[1,0,0]
    v_pk_mul_f32 v[70:71], v[32:33], v[8:9] op_sel:[0,0] op_sel_hi:[1,0]
    v_pk_fma_f32 v[34:35], v[32:33], v[8:9], v[70:71] op_sel:[1,1,0] op_sel_hi:[0,1,1] neg_lo:[1,0,0]
    v_cvt_pk_bf16_f32 v127, v32, v34
    v_cvt_pk_bf16_f32 v131, -v33, -v35
    ds_write_b128 v110, v[124:127] offset:16384
    ds_write_b128 v110, v[128:131] offset:24576
    v_cvt_pk_bf16_f32 v81, v62, v10
    v_cvt_pk_bf16_f32 v85, v63, v11
    v_pk_mul_f32 v[66:67], v[62:63], v[14:15] op_sel:[0,0] op_sel_hi:[1,0]
    v_pk_mul_f32 v[68:69], v[10:11], v[14:15] op_sel:[0,0] op_sel_hi:[1,0]
    v_pk_fma_f32 v[62:63], v[62:63], v[14:15], v[66:67] op_sel:[1,1,0] op_sel_hi:[0,1,1] neg_lo:[1,0,0]
    v_pk_fma_f32 v[10:11], v[10:11], v[14:15], v[68:69] op_sel:[1,1,0] op_sel_hi:[0,1,1] neg_lo:[1,0,0]
    buffer_load_dwordx4 v[176:179], v220, s[32:35], s49 offen
    s_add_u32 s49, s49, s55
    v_pk_mul_f32 v[70:71], v[20:21], v[12:13] op_sel:[0,0] op_sel_hi:[1,0]
    v_pk_fma_f32 v[36:37], v[20:21], v[12:13], v[70:71] op_sel:[1,1,0] op_sel_hi:[0,1,1] neg_lo:[1,0,0]
    v_cvt_pk_bf16_f32 v82, v62, v10
    v_cvt_pk_bf16_f32 v86, v63, v11
    v_pk_mul_f32 v[66:67], v[62:63], v[14:15] op_sel:[0,0] op_sel_hi:[1,0]
    v_pk_mul_f32 v[68:69], v[10:11], v[14:15] op_sel:[0,0] op_sel_hi:[1,0]
    v_pk_fma_f32 v[62:63], v[62:63], v[14:15], v[66:67] op_sel:[1,1,0] op_sel_hi:[0,1,1] neg_lo:[1,0,0]
    v_pk_fma_f32 v[10:11], v[10:11], v[14:15], v[68:69] op_sel:[1,1,0] op_sel_hi:[0,1,1] neg_lo:[1,0,0]
    v_pk_mul_f32 v[70:71], v[24:25], v[12:13] op_sel:[0,0] op_sel_hi:[1,0]
    v_pk_fma_f32 v[38:39], v[24:25], v[12:13], v[70:71] op_sel:[1,1,0] op_sel_hi:[0,1,1] neg_lo:[1,0,0]
    v_cvt_pk_bf16_f32 v132, v36, v38
    v_cvt_pk_bf16_f32 v136, -v37, -v39
    v_cvt_pk_bf16_f32 v83, v62, v10
    v_cvt_pk_bf16_f32 v87, v63, v11
    v_pk_mul_f32 v[66:67], v[62:63], v[14:15] op_sel:[0,0] op_sel_hi:[1,0]
    v_pk_mul_f32 v[68:69], v[10:11], v[14:15] op_sel:[0,0] op_sel_hi:[1,0]
    v_pk_fma_f32 v[62:63], v[62:63], v[14:15], v[66:67] op_sel:[1,1,0] op_sel_hi:[0,1,1] neg_lo:[1,0,0]
    v_pk_fma_f32 v[10:11], v[10:11], v[14:15], v[68:69] op_sel:[1,1,0] op_sel_hi:[0,1,1] neg_lo:[1,0,0]
    ds_write_b128 v111, v[80:83]
    ds_write_b128 v111, v[84:87] offset:8192
    v_pk_mul_f32 v[70:71], v[28:29], v[12:13] op_sel:[0,0] op_sel_hi:[1,0]
    v_pk_fma_f32 v[40:41], v[28:29], v[12:13], v[70:71] op_sel:[1,1,0] op_sel_hi:[0,1,1] neg_lo:[1,0,0]
    v_pk_mul_f32 v[70:71], v[32:33], v[12:13] op_sel:[0,0] op_sel_hi:[1,0]
    v_pk_fma_f32 v[42:43], v[32:33], v[12:13], v[70:71] op_sel:[1,1,0] op_sel_hi:[0,1,1] neg_lo:[1,0,0]
    v_cvt_pk_bf16_f32 v133, v40, v42
    v_cvt_pk_bf16_f32 v137, -v41, -v43
    v_cvt_pk_bf16_f32 v72, v62, v10
    v_cvt_pk_bf16_f32 v76, v63, v11
    v_pk_mul_f32 v[66:67], v[62:63], v[14:15] op_sel:[0,0] op_sel_hi:[1,0]
    v_pk_mul_f32 v[68:69], v[10:11], v[14:15] op_sel:[0,0] op_sel_hi:[1,0]
    v_pk_fma_f32 v[62:63], v[62:63], v[14:15], v[66:67] op_sel:[1,1,0] op_sel_hi:[0,1,1] neg_lo:[1,0,0]
    v_pk_fma_f32 v[10:11], v[10:11], v[14:15], v[68:69] op_sel:[1,1,0] op_sel_hi:[0,1,1] neg_lo:[1,0,0]
    buffer_load_dwordx4 v[180:183], v220, s[32:35], s49 offen
    s_add_u32 s49, s49, s55
    v_pk_mul_f32 v[70:71], v[36:37], v[12:13] op_sel:[0,0] op_sel_hi:[1,0]
    v_pk_fma_f32 v[44:45], v[36:37], v[12:13], v[70:71] op_sel:[1,1,0] op_sel_hi:[0,1,1] neg_lo:[1,0,0]
    v_cvt_pk_bf16_f32 v73, v62, v10
    v_cvt_pk_bf16_f32 v77, v63, v11
    v_pk_mul_f32 v[66:67], v[62:63], v[14:15] op_sel:[0,0] op_sel_hi:[1,0]
    v_pk_mul_f32 v[68:69], v[10:11], v[14:15] op_sel:[0,0] op_sel_hi:[1,0]
    v_pk_fma_f32 v[62:63], v[62:63], v[14:15], v[66:67] op_sel:[1,1,0] op_sel_hi:[0,1,1] neg_lo:[1,0,0]
    v_pk_fma_f32 v[10:11], v[10:11], v[14:15], v[68:69] op_sel:[1,1,0] op_sel_hi:[0,1,1] neg_lo:[1,0,0]
    v_pk_mul_f32 v[70:71], v[40:41], v[12:13] op_sel:[0,0] op_sel_hi:[1,0]
    v_pk_fma_f32 v[46:47], v[40:41], v[12:13], v[70:71] op_sel:[1,1,0] op_sel_hi:[0,1,1] neg_lo:[1,0,0]
    v_cvt_pk_bf16_f32 v134, v44, v46
    v_cvt_pk_bf16_f32 v138, -v45, -v47
    v_cvt_pk_bf16_f32 v74, v62, v10
    v_cvt_pk_bf16_f32 v78, v63, v11
    v_pk_mul_f32 v[66:67], v[62:63], v[14:15] op_sel:[0,0] op_sel_hi:[1,0]
    v_pk_mul_f32 v[68:69], v[10:11], v[14:15] op_sel:[0,0] op_sel_hi:[1,0]
    v_pk_fma_f32 v[62:63], v[62:63], v[14:15], v[66:67] op_sel:[1,1,0] op_sel_hi:[0,1,1] neg_lo:[1,0,0]
    v_pk_fma_f32 v[10:11], v[10:11], v[14:15], v[68:69] op_sel:[1,1,0] op_sel_hi:[0,1,1] neg_lo:[1,0,0]
    v_pk_mul_f32 v[70:71], v[44:45], v[12:13] op_sel:[0,0] op_sel_hi:[1,0]
    v_pk_fma_f32 v[48:49], v[44:45], v[12:13], v[70:71] op_sel:[1,1,0] op_sel_hi:[0,1,1] neg_lo:[1,0,0]
    v_cvt_pk_bf16_f32 v75, v62, v10
    v_cvt_pk_bf16_f32 v79, v63, v11
    v_pk_mul_f32 v[66:67], v[62:63], v[14:15] op_sel:[0,0] op_sel_hi:[1,0]
    v_pk_mul_f32 v[68:69], v[10:11], v[14:15] op_sel:[0,0] op_sel_hi:[1,0]
    v_pk_fma_f32 v[62:63], v[62:63], v[14:15], v[66:67] op_sel:[1,1,0] op_sel_hi:[0,1,1] neg_lo:[1,0,0]
    v_pk_fma_f32 v[10:11], v[10:11], v[14:15], v[68:69] op_sel:[1,1,0] op_sel_hi:[0,1,1] neg_lo:[1,0,0]
    ds_write_b128 v112, v[72:75]
    ds_write_b128 v112, v[76:79] offset:8192
    v_pk_mul_f32 v[70:71], v[46:47], v[12:13] op_sel:[0,0] op_sel_hi:[1,0]
    v_pk_fma_f32 v[50:51], v[46:47], v[12:13], v[70:71] op_sel:[1,1,0] op_sel_hi:[0,1,1] neg_lo:[1,0,0]
    v_cvt_pk_bf16_f32 v135, v48, v50
    v_cvt_pk_bf16_f32 v139, -v49, -v51
    ds_write_b128 v111, v[132:135] offset:16384
    ds_write_b128 v111, v[136:139] offset:24576
    buffer_load_dwordx4 v[184:187], v220, s[32:35], s49 offen
    s_add_u32 s49, s49, s55
    v_pk_mul_f32 v[70:71], v[48:49], v[12:13] op_sel:[0,0] op_sel_hi:[1,0]
    v_pk_fma_f32 v[52:53], v[48:49], v[12:13], v[70:71] op_sel:[1,1,0] op_sel_hi:[0,1,1] neg_lo:[1,0,0]
    v_cvt_pk_bf16_f32 v80, v62, v10
    v_cvt_pk_bf16_f32 v84, v63, v11
    v_pk_mul_f32 v[66:67], v[62:63], v[14:15] op_sel:[0,0] op_sel_hi:[1,0]
    v_pk_mul_f32 v[68:69], v[10:11], v[14:15] op_sel:[0,0] op_sel_hi:[1,0]
    v_pk_fma_f32 v[62:63], v[62:63], v[14:15], v[66:67] op_sel:[1,1,0] op_sel_hi:[0,1,1] neg_lo:[1,0,0]
    v_pk_fma_f32 v[10:11], v[10:11], v[14:15], v[68:69] op_sel:[1,1,0] op_sel_hi:[0,1,1] neg_lo:[1,0,0]
    v_pk_mul_f32 v[70:71], v[52:53], v[12:13] op_sel:[0,0] op_sel_hi:[1,0]
    v_pk_fma_f32 v[54:55], v[52:53], v[12:13], v[70:71] op_sel:[1,1,0] op_sel_hi:[0,1,1] neg_lo:[1,0,0]
    v_cvt_pk_bf16_f32 v124, v52, v54
    v_cvt_pk_bf16_f32 v128, -v53, -v55
    v_cvt_pk_bf16_f32 v81, v62, v10
    v_cvt_pk_bf16_f32 v85, v63, v11
    v_pk_mul_f32 v[66:67], v[62:63], v[14:15] op_sel:[0,0] op_sel_hi:[1,0]
    v_pk_mul_f32 v[68:69], v[10:11], v[14:15] op_sel:[0,0] op_sel_hi:[1,0]
    v_pk_fma_f32 v[62:63], v[62:63], v[14:15], v[66:67] op_sel:[1,1,0] op_sel_hi:[0,1,1] neg_lo:[1,0,0]
    v_pk_fma_f32 v[10:11], v[10:11], v[14:15], v[68:69] op_sel:[1,1,0] op_sel_hi:[0,1,1] neg_lo:[1,0,0]
    v_pk_mul_f32 v[70:71], v[54:55], v[12:13] op_sel:[0,0] op_sel_hi:[1,0]
    v_pk_fma_f32 v[56:57], v[54:55], v[12:13], v[70:71] op_sel:[1,1,0] op_sel_hi:[0,1,1] neg_lo:[1,0,0]
    v_cvt_pk_bf16_f32 v82, v62, v10
    v_cvt_pk_bf16_f32 v86, v63, v11
    v_pk_mul_f32 v[66:67], v[62:63], v[14:15] op_sel:[0,0] op_sel_hi:[1,0]
    v_pk_mul_f32 v[68:69], v[10:11], v[14:15] op_sel:[0,0] op_sel_hi:[1,0]
    v_pk_fma_f32 v[62:63], v[62:63], v[14:15], v[66:67] op_sel:[1,1,0] op_sel_hi:[0,1,1] neg_lo:[1,0,0]
    v_pk_fma_f32 v[10:11], v[10:11], v[14:15], v[68:69] op_sel:[1,1,0] op_sel_hi:[0,1,1] neg_lo:[1,0,0]
    buffer_load_dwordx4 v[188:191], v220, s[32:35], s49 offen
    s_add_u32 s49, s49, s55
    v_pk_mul_f32 v[70:71], v[56:57], v[12:13] op_sel:[0,0] op_sel_hi:[1,0]
    v_pk_fma_f32 v[58:59], v[56:57], v[12:13], v[70:71] op_sel:[1,1,0] op_sel_hi:[0,1,1] neg_lo:[1,0,0]
    v_cvt_pk_bf16_f32 v125, v56, v58
    v_cvt_pk_bf16_f32 v129, -v57, -v59
    v_cvt_pk_bf16_f32 v83, v62, v10
    v_cvt_pk_bf16_f32 v87, v63, v11
    ds_write_b128 v113, v[80:83]
    ds_write_b128 v113, v[84:87] offset:8192
    v_pk_mul_f32 v[70:71], v[58:59], v[12:13] op_sel:[0,0] op_sel_hi:[1,0]
    v_pk_fma_f32 v[60:61], v[58:59], v[12:13], v[70:71] op_sel:[1,1,0] op_sel_hi:[0,1,1] neg_lo:[1,0,0]
    v_cvt_pk_bf16_f32 v126, v60, v60
    v_cvt_pk_bf16_f32 v130, -v61, -v61
    ds_write_b128 v112, v[124:127] offset:16384
    ds_write_b128 v112, v[128:131] offset:24576
    s_mov_b64 exec, 1
    ds_add_u32 v253, v254 offset:0
    s_mov_b64 exec, -1
    s_mul_i32 s53, s60, 1536
    s_add_u32 s53, s53, 65536
L_ka_w1:
    ds_read_b32 v255, v253 offset:0
    s_waitcnt lgkmcnt(0)
    v_readfirstlane_b32 s63, v255
    s_nop 0
    s_cmp_lt_u32 s63, 2
    s_cbranch_scc1 L_ka_w1
    ds_read_b64_tr_b16 v[2:3], v104 offset:0
    ds_read_b64_tr_b16 v[4:5], v105 offset:256
    ds_read_b64_tr_b16 v[6:7], v100 offset:16384
    ds_read_b64_tr_b16 v[8:9], v101 offset:16640
    ds_read_b64_tr_b16 v[10:11], v101 offset:16384
    ds_read_b64_tr_b16 v[12:13], v100 offset:16640
    ds_read_b64_tr_b16 v[14:15], v104 offset:2048
    ds_read_b64_tr_b16 v[16:17], v105 offset:2304
    ds_read_b64_tr_b16 v[18:19], v100 offset:18432
    ds_read_b64_tr_b16 v[20:21], v101 offset:18688
    ds_read_b64_tr_b16 v[22:23], v101 offset:18432
    ds_read_b64_tr_b16 v[24:25], v100 offset:18688
    ds_read_b64_tr_b16 v[26:27], v104 offset:4096
    ds_read_b64_tr_b16 v[28:29], v105 offset:4352
    ds_read_b64_tr_b16 v[30:31], v100 offset:20480
    ds_read_b64_tr_b16 v[32:33], v101 offset:20736
    ds_read_b64_tr_b16 v[34:35], v101 offset:20480
    ds_read_b64_tr_b16 v[36:37], v100 offset:20736
    buffer_load_dwordx4 v[192:195], v220, s[32:35], s49 offen
    s_add_u32 s49, s49, s55
    v_and_b32 v74, 0xffff, v140
    v_lshrrev_b32 v75, 16, v140
    v_and_b32 v76, 0xffff, v141
    v_lshrrev_b32 v77, 16, v141
    s_waitcnt lgkmcnt(12)
    v_mfma_f32_16x16x32_bf16 v[64:67], v[6:9], v[2:5], 0
    v_mfma_f32_16x16x32_bf16 v[68:71], v[10:13], v[2:5], 0
    ds_read_b64_tr_b16 v[38:39], v104 offset:6144
    ds_read_b64_tr_b16 v[40:41], v105 offset:6400
    ds_read_b64_tr_b16 v[42:43], v100 offset:22528
    ds_read_b64_tr_b16 v[44:45], v101 offset:22784
    ds_read_b64_tr_b16 v[46:47], v101 offset:22528
    ds_read_b64_tr_b16 v[48:49], v100 offset:22784
    v_and_b32 v78, 0xffff, v142
    v_lshrrev_b32 v79, 16, v142
    v_and_b32 v80, 0xffff, v143
    v_lshrrev_b32 v81, 16, v143
    s_waitcnt lgkmcnt(12)
    v_mfma_f32_16x16x32_bf16 v[64:67], v[18:21], v[14:17], v[64:67]
    v_mfma_f32_16x16x32_bf16 v[68:71], v[22:25], v[14:17], v[68:71]
    ds_read_b64_tr_b16 v[50:51], v104 offset:8192
    ds_read_b64_tr_b16 v[52:53], v105 offset:8448
    ds_read_b64_tr_b16 v[54:55], v100 offset:24576
    ds_read_b64_tr_b16 v[56:57], v101 offset:24832
    ds_read_b64_tr_b16 v[58:59], v101 offset:24576
    ds_read_b64_tr_b16 v[60:61], v100 offset:24832
    v_and_b32 v82, 0xffff, v144
    v_lshrrev_b32 v83, 16, v144
    v_and_b32 v84, 0xffff, v145
    v_lshrrev_b32 v85, 16, v145
    s_waitcnt lgkmcnt(12)
    v_mfma_f32_16x16x32_bf16 v[64:67], v[30:33], v[26:29], v[64:67]
    v_mfma_f32_16x16x32_bf16 v[68:71], v[34:37], v[26:29], v[68:71]
    ds_read_b64_tr_b16 v[2:3], v104 offset:10240
    ds_read_b64_tr_b16 v[4:5], v105 offset:10496
    ds_read_b64_tr_b16 v[6:7], v100 offset:26624
    ds_read_b64_tr_b16 v[8:9], v101 offset:26880
    ds_read_b64_tr_b16 v[10:11], v101 offset:26624
    ds_read_b64_tr_b16 v[12:13], v100 offset:26880
    v_and_b32 v86, 0xffff, v146
    v_lshrrev_b32 v87, 16, v146
    v_and_b32 v88, 0xffff, v147
    v_add_u32 v74, s53, v74
    s_waitcnt lgkmcnt(12)
    v_mfma_f32_16x16x32_bf16 v[64:67], v[42:45], v[38:41], v[64:67]
    v_mfma_f32_16x16x32_bf16 v[68:71], v[46:49], v[38:41], v[68:71]
    ds_read_b64_tr_b16 v[14:15], v104 offset:12288
    ds_read_b64_tr_b16 v[16:17], v105 offset:12544
    ds_read_b64_tr_b16 v[18:19], v100 offset:28672
    ds_read_b64_tr_b16 v[20:21], v101 offset:28928
    ds_read_b64_tr_b16 v[22:23], v101 offset:28672
    ds_read_b64_tr_b16 v[24:25], v100 offset:28928
    buffer_load_dwordx4 v[196:199], v220, s[32:35], s49 offen
    s_add_u32 s49, s49, s55
    v_add_u32 v75, s53, v75
    v_add_u32 v76, s53, v76
    v_add_u32 v77, s53, v77
    v_add_u32 v78, s53, v78
    s_waitcnt lgkmcnt(12)
    v_mfma_f32_16x16x32_bf16 v[64:67], v[54:57], v[50:53], v[64:67]
    v_mfma_f32_16x16x32_bf16 v[68:71], v[58:61], v[50:53], v[68:71]
    ds_read_b64_tr_b16 v[26:27], v104 offset:14336
    ds_read_b64_tr_b16 v[28:29], v105 offset:14592
    ds_read_b64_tr_b16 v[30:31], v100 offset:30720
    ds_read_b64_tr_b16 v[32:33], v101 offset:30976
    ds_read_b64_tr_b16 v[34:35], v101 offset:30720
    ds_read_b64_tr_b16 v[36:37], v100 offset:30976
    v_add_u32 v79, s53, v79
    v_add_u32 v80, s53, v80
    v_add_u32 v81, s53, v81
    v_add_u32 v82, s53, v82
    s_waitcnt lgkmcnt(12)
    v_mfma_f32_16x16x32_bf16 v[64:67], v[6:9], v[2:5], v[64:67]
    v_mfma_f32_16x16x32_bf16 v[68:71], v[10:13], v[2:5], v[68:71]
    v_add_u32 v83, s53, v83
    v_add_u32 v84, s53, v84
    v_add_u32 v85, s53, v85
    v_add_u32 v86, s53, v86
    s_waitcnt lgkmcnt(6)
    v_mfma_f32_16x16x32_bf16 v[64:67], v[18:21], v[14:17], v[64:67]
    v_mfma_f32_16x16x32_bf16 v[68:71], v[22:25], v[14:17], v[68:71]
    v_add_u32 v87, s53, v87
    v_add_u32 v88, s53, v88
    s_waitcnt lgkmcnt(0)
    v_mfma_f32_16x16x32_bf16 v[64:67], v[30:33], v[26:29], v[64:67]
    v_mfma_f32_16x16x32_bf16 v[68:71], v[34:37], v[26:29], v[68:71]
    s_nop 6
    v_cvt_pk_bf16_f32 v72, v64, v65
    v_cvt_pk_bf16_f32 v73, v66, v67
    ds_write_b16 v116, v72
    ds_write_b16_d16_hi v117, v72
    ds_write_b16 v118, v73
    ds_write_b16_d16_hi v119, v73
    v_cvt_pk_bf16_f32 v72, v68, v69
    v_cvt_pk_bf16_f32 v73, v70, v71
    ds_write_b16 v120, v72
    ds_write_b16_d16_hi v121, v72
    ds_write_b16 v122, v73
    ds_write_b16_d16_hi v123, v73
    s_mov_b64 exec, 1
    ds_add_u32 v253, v254 offset:4
    s_mov_b64 exec, -1
L_ka_w2:
    ds_read_b32 v255, v253 offset:4
    s_waitcnt lgkmcnt(0)
    v_readfirstlane_b32 s63, v255
    s_nop 0
    s_cmp_lt_u32 s63, 2
    s_cbranch_scc1 L_ka_w2
    ds_read_u16 v2, v74
    ds_read_u16 v3, v75
    ds_read_u16 v4, v76
    ds_read_u16 v5, v77
    ds_read_u16 v6, v78
    ds_read_u16 v7, v79
    ds_read_u16 v8, v80
    ds_read_u16 v9, v81
    ds_read_u16 v10, v82
    ds_read_u16 v11, v83
    ds_read_u16 v12, v84
    ds_read_u16 v13, v85
    ds_read_u16 v14, v86
    ds_read_u16 v15, v87
    ds_read_u16 v16, v88
    s_waitcnt lgkmcnt(6)
    v_lshl_or_b32 v20, v3, 16, v2
    v_lshl_or_b32 v21, v5, 16, v4
    v_lshl_or_b32 v22, v7, 16, v6
    v_lshl_or_b32 v23, v9, 16, v8
    ds_write_b128 v114, v[20:23] offset:14784
    v_lshl_or_b32 v38, v4, 16, v3
    v_lshl_or_b32 v39, v6, 16, v5
    v_lshl_or_b32 v40, v8, 16, v7
    v_lshl_or_b32 v41, v10, 16, v9
    ds_write_b128 v114, v[38:41] offset:12672
    s_waitcnt lgkmcnt(2)
    v_lshl_or_b32 v30, v5, 16, v4
    v_lshl_or_b32 v31, v7, 16, v6
    v_lshl_or_b32 v32, v9, 16, v8
    v_lshl_or_b32 v33, v11, 16, v10
    ds_write_b128 v114, v[30:33] offset:10560
    v_lshl_or_b32 v48, v6, 16, v5
    v_lshl_or_b32 v49, v8, 16, v7
    v_lshl_or_b32 v50, v10, 16, v9
    v_lshl_or_b32 v51, v12, 16, v11
    ds_write_b128 v114, v[48:51] offset:8448
    v_lshl_or_b32 v24, v11, 16, v10
    v_lshl_or_b32 v25, v13, 16, v12
    ds_write_b128 v114, v[22:25] offset:6336
    v_lshl_or_b32 v42, v12, 16, v11
    v_lshl_or_b32 v43, v14, 16, v13
    ds_write_b128 v114, v[40:43] offset:4224
    v_lshl_or_b32 v34, v13, 16, v12
    v_lshl_or_b32 v35, v15, 16, v14
    ds_write_b128 v114, v[32:35] offset:2112
    v_lshl_or_b32 v52, v14, 16, v13
    v_lshl_or_b32 v53, v16, 16, v15
    ds_write_b128 v114, v[50:53] offset:0
    s_mov_b64 exec, 1
    ds_add_u32 v253, v254 offset:8
    s_mov_b64 exec, -1
L_ka_w3:
    ds_read_b32 v255, v253 offset:8
    s_waitcnt lgkmcnt(0)
    v_readfirstlane_b32 s63, v255
    s_nop 0
    s_cmp_lt_u32 s63, 2
    s_cbranch_scc1 L_ka_w3
    ds_read_b128 v[32:35], v228 offset:1024
    ds_read_b128 v[36:39], v228 offset:960
    ds_read_b128 v[40:43], v228 offset:896
    ds_read_b128 v[44:47], v228 offset:832
    ds_read_b128 v[48:51], v228 offset:768
    ds_read_b128 v[52:55], v228 offset:704
    ds_read_b128 v[56:59], v228 offset:640
    ds_read_b128 v[60:63], v228 offset:576
    ds_read_b128 v[64:67], v228 offset:512
    ds_read_b128 v[68:71], v228 offset:448
    ds_read_b128 v[72:75], v228 offset:384
    ds_read_b128 v[76:79], v228 offset:320
    ds_read_b128 v[80:83], v228 offset:256
    ds_read_b128 v[84:87], v228 offset:192
    ds_read_b128 v[88:91], v228 offset:128
    ds_read_b128 v[92:95], v228 offset:64
    ds_read_b128 v[96:99], v228 offset:0
    s_cmp_eq_u32 s62, 0
    s_cbranch_scc1 L_ka_pr0
    ds_read_b128 v[104:107], v229 offset:5760
    ds_read_b128 v[108:111], v229 offset:5696
    ds_read_b128 v[112:115], v229 offset:5632
    ds_read_b128 v[116:119], v229 offset:5568
L_ka_pr0:
    s_mov_b64 exec, 1
    ds_add_u32 v252, v254 offset:8
    s_mov_b64 exec, -1
    s_branch L_ka_warm0
L_ka_back0:
    s_branch L_ka_warm1
L_ka_back1:
    s_waitcnt vmcnt(0)
    s_mov_b32 s37, 0x05040100
    s_mov_b32 s38, 0x07060302
    s_mov_b32 s32, s58
    s_mov_b32 s33, s59
    s_cmp_ge_u32 s45, 2
    s_cselect_b32 s34, 27262976, 0
    s_mov_b32 s52, 0
    v_mov_b32 v220, 0
    v_mov_b32 v221, 0
    s_cmp_eq_u32 s45, 0
    s_cbranch_scc1 L_aux_done
    s_cmp_lg_u32 s45, 3
    s_cbranch_scc1 L_aux_nc
    v_lshl_add_u32 v2, v1, 4, s51
    v_subrev_u32 v2, 3584, v2
    v_cmp_gt_u32 vcc, 56, v1
    v_mov_b32 v3, 0x7fff0000
    s_nop 0
    v_cndmask_b32 v220, v3, v2, vcc
    v_add_u32 v221, 896, v220
    s_movk_i32 s55, 1792
    v_mov_b64 v[120:121], v[168:169]
    v_mov_b64 v[122:123], v[170:171]
    v_mov_b64 v[136:137], v[172:173]
    v_mov_b64 v[138:139], v[174:175]
    v_mov_b64 v[124:125], v[176:177]
    v_mov_b64 v[126:127], v[178:179]
    v_mov_b64 v[140:141], v[180:181]
    v_mov_b64 v[142:143], v[182:183]
    v_mov_b64 v[128:129], v[184:185]
    v_mov_b64 v[130:131], v[186:187]
    v_mov_b64 v[100:101], v[188:189]
    v_mov_b64 v[102:103], v[190:191]
    v_mov_b64 v[132:133], v[192:193]
    v_mov_b64 v[134:135], v[194:195]
    v_mov_b64 v[28:29], v[196:197]
    v_mov_b64 v[30:31], v[198:199]
    s_branch L_aux_done
L_aux_nc:
    v_perm_b32 v120, v172, v168, s37
    v_perm_b32 v121, v180, v176, s37
    v_perm_b32 v122, v188, v184, s37
    v_perm_b32 v123, v196, v192, s37
    v_perm_b32 v124, v172, v168, s38
    v_perm_b32 v125, v180, v176, s38
    v_perm_b32 v126, v188, v184, s38
    v_perm_b32 v127, v196, v192, s38
    v_perm_b32 v128, v173, v169, s37
    v_perm_b32 v129, v181, v177, s37
    v_perm_b32 v130, v189, v185, s37
    v_perm_b32 v131, v197, v193, s37
    v_perm_b32 v132, v173, v169, s38
    v_perm_b32 v133, v181, v177, s38
    v_perm_b32 v134, v189, v185, s38
    v_perm_b32 v135, v197, v193, s38
    v_perm_b32 v136, v174, v170, s37
    v_perm_b32 v137, v182, v178, s37
    v_perm_b32 v138, v190, v186, s37
    v_perm_b32 v139, v198, v194, s37
    v_perm_b32 v140, v174, v170, s38
    v_perm_b32 v141, v182, v178, s38
    v_perm_b32 v142, v190, v186, s38
    v_perm_b32 v143, v198, v194, s38
    v_perm_b32 v100, v175, v171, s37
    v_perm_b32 v101, v183, v179, s37
    v_perm_b32 v102, v191, v187, s37
    v_perm_b32 v103, v199, v195, s37
    v_perm_b32 v28, v175, v171, s38
    v_perm_b32 v29, v183, v179, s38
    v_perm_b32 v30, v191, v187, s38
    v_perm_b32 v31, v199, v195, s38
    v_lshrrev_b32 v3, 4, v1
    v_and_b32 v2, 7, v1
    s_cmp_eq_u32 s45, 2
    s_cbranch_scc1 L_aux_w2
    v_mov_b32 v4, 0x3f803f80
    v_mov_b32 v5, 0x3f803f80
    v_mov_b32 v6, 0x3f803f80
    v_mov_b32 v7, 0x3f803f80
    s_nop 1
    v_mfma_f32_16x16x32_bf16 v[168:171], v[4:7], v[120:123], 0
    v_mfma_f32_16x16x32_bf16 v[172:175], v[4:7], v[124:127], 0
    v_mfma_f32_16x16x32_bf16 v[176:179], v[4:7], v[128:131], 0
    v_mfma_f32_16x16x32_bf16 v[180:183], v[4:7], v[132:135], 0
    v_mfma_f32_16x16x32_bf16 v[184:187], v[4:7], v[136:139], 0
    v_mfma_f32_16x16x32_bf16 v[188:191], v[4:7], v[140:143], 0
    v_mfma_f32_16x16x32_bf16 v[192:195], v[4:7], v[100:103], 0
    v_mfma_f32_16x16x32_bf16 v[196:199], v[4:7], v[28:31], 0
    s_mul_i32 s49, s48, 14336
    s_and_b32 s50, s46, 1
    s_mul_i32 s50, s50, 7168
    s_add_u32 s49, s49, s50
    s_lshl_b32 s50, s47, 8
    s_add_u32 s49, s49, s50
    s_add_u32 s49, s49, 6848512
    v_lshl_add_u32 v2, v2, 5, s49
    v_lshl_add_u32 v2, v3, 3, v2
    v_cmp_eq_u32 vcc, 1, v3
    s_nop 1
    v_cndmask_b32 v168, v168, v176, vcc
    v_cndmask_b32 v172, v172, v180, vcc
    v_cmp_eq_u32 vcc, 2, v3
    s_nop 1
    v_cndmask_b32 v168, v168, v184, vcc
    v_cndmask_b32 v172, v172, v188, vcc
    v_cmp_eq_u32 vcc, 3, v3
    s_nop 1
    v_cndmask_b32 v168, v168, v192, vcc
    v_cndmask_b32 v172, v172, v196, vcc
    s_nop 0
    v_add_f32_dpp v168, v168, v168 row_ror:8 row_mask:0xf bank_mask:0xf
    v_add_f32_dpp v172, v172, v172 row_ror:8 row_mask:0xf bank_mask:0xf
    v_cvt_pk_bf16_f32 v169, v168, v168
    v_lshlrev_b32 v169, 16, v169
    v_sub_f32 v169, v168, v169
    v_cvt_pk_bf16_f32 v176, v168, v169
    v_cvt_pk_bf16_f32 v173, v172, v172
    v_lshlrev_b32 v173, 16, v173
    v_sub_f32 v173, v172, v173
    v_cvt_pk_bf16_f32 v177, v172, v173
    s_mov_b32 exec_lo, 0x00ff00ff
    s_mov_b32 exec_hi, 0x00ff00ff
    global_store_dwordx2 v2, v[176:177], s[58:59] sc1
    s_mov_b64 exec, -1
    s_branch L_aux_done
L_aux_w2:
    s_mul_i32 s49, s48, 229376
    s_add_u32 s49, s49, 12582912
    v_lshl_add_u32 v2, v2, 4, s49
    v_bfe_u32 v4, v1, 3, 1
    v_lshl_add_u32 v3, v4, 2, v3
    s_lshl_b32 s50, s47, 3
    v_add_u32 v3, s50, v3
    v_mul_u32_u24 v4, 9363, v3
    v_lshrrev_b32 v4, 16, v4
    v_mul_u32_u24 v5, 7, v4
    v_sub_u32 v5, v3, v5
    v_cmp_gt_u32 vcc, 4, v5
    v_lshl_add_u32 v5, v4, 2, v5
    v_sub_u32 v6, v5, v4
    v_add_u32 v6, 124, v6
    v_cndmask_b32 v5, v6, v5, vcc
    v_lshrrev_b32 v4, 2, v5
    v_lshl_add_u32 v2, v4, 12, v2
    v_and_b32 v5, 3, v5
    v_lshl_add_u32 v2, v5, 8, v2
    v_mov_b32 v220, v2
    v_add_u32 v221, 128, v2
    s_movk_i32 s55, 1024
L_aux_done:
L_ka_w4:
    ds_read_b32 v255, v252 offset:8
    s_waitcnt lgkmcnt(0)
    v_readfirstlane_b32 s63, v255
    s_nop 0
    s_cmp_lt_u32 s63, 8
    s_cbranch_scc1 L_ka_w4
    buffer_store_dwordx4 v[120:123], v220, s[32:35], s52 offen sc1
    buffer_store_dwordx4 v[136:139], v221, s[32:35], s52 offen sc1
    s_add_u32 s52, s52, s55
    buffer_store_dwordx4 v[124:127], v220, s[32:35], s52 offen sc1
    buffer_store_dwordx4 v[140:143], v221, s[32:35], s52 offen sc1
    s_add_u32 s52, s52, s55
    buffer_store_dwordx4 v[128:131], v220, s[32:35], s52 offen sc1
    buffer_store_dwordx4 v[100:103], v221, s[32:35], s52 offen sc1
    s_add_u32 s52, s52, s55
    buffer_store_dwordx4 v[132:135], v220, s[32:35], s52 offen sc1
    buffer_store_dwordx4 v[28:31], v221, s[32:35], s52 offen sc1
    s_add_u32 s52, s52, s55
    s_cmp_eq_u32 s61, 0
    s_cbranch_scc1 L_ka_r0
    s_branch L_ka_r1
L_ka_ln:
    s_mov_b32 s40, 0x3f803f80
    s_mov_b32 s37, 0x05040100
    s_mov_b32 s38, 0x07060302
    v_bfe_u32 v60, v0, 2, 1
    v_lshlrev_b32 v60, 4, v60
    v_lshl_add_u32 v64, v62, 5, v60
    v_add_u32 v64, 69632, v64
    v_xor_b32 v65, 16, v64
    v_bfe_u32 v60, v0, 3, 1
    v_xor_b32 v60, v60, v1
    s_lshl_b32 s28, s39, 11
    s_add_u32 s29, s28, 69632
    v_lshl_add_u32 v6, v60, 4, s29
    s_mul_i32 s3, s2, 8320
    s_add_u32 s3, s3, s28
    v_lshl_add_u32 v7, v1, 4, s3
    s_mul_i32 s28, s2, 64
    s_add_u32 s28, s28, 4456448
    v_lshl_add_u32 v30, v1, 4, s28
    s_lshl_b32 s29, s39, 3
    s_add_u32 s29, s29, 154176
    v_mov_b32 v31, s29
    v_and_b32 v36, 3, v1
    v_lshl_add_u32 v36, v36, 4, v252
    v_mov_b32 v86, 1
    v_mov_b32 v87, 0
    s_waitcnt vmcnt(4)
    v_perm_b32 v56, v17, v16, s37
    v_perm_b32 v32, v17, v16, s38
    v_perm_b32 v57, v19, v18, s37
    v_perm_b32 v33, v19, v18, s38
    v_perm_b32 v58, v21, v20, s37
    v_perm_b32 v34, v21, v20, s38
    v_perm_b32 v59, v23, v22, s37
    v_perm_b32 v35, v23, v22, s38
    ds_write_b128 v64, v[56:59]
    ds_write_b128 v65, v[32:35]
    ds_read_b128 v[40:43], v6
    ds_read_b128 v[44:47], v6 offset:1024
    s_waitcnt vmcnt(2)
    v_dot2_f32_bf16 v24, v8, s40, 0
    v_dot2_f32_bf16 v25, v12, s40, 0
    v_dot2_f32_bf16 v26, v8, v8, 0
    v_dot2_f32_bf16 v27, v12, v12, 0
    v_dot2_f32_bf16 v24, v9, s40, v24
    v_dot2_f32_bf16 v25, v13, s40, v25
    v_dot2_f32_bf16 v26, v9, v9, v26
    v_dot2_f32_bf16 v27, v13, v13, v27
    v_dot2_f32_bf16 v24, v10, s40, v24
    v_dot2_f32_bf16 v25, v14, s40, v25
    v_dot2_f32_bf16 v26, v10, v10, v26
    v_dot2_f32_bf16 v27, v14, v14, v27
    v_dot2_f32_bf16 v24, v11, s40, v24
    v_dot2_f32_bf16 v25, v15, s40, v25
    v_dot2_f32_bf16 v26, v11, v11, v26
    v_dot2_f32_bf16 v27, v15, v15, v27
    v_add_f32_dpp v24, v24, v24 row_shr:1 row_mask:0xf bank_mask:0xf
    v_add_f32_dpp v25, v25, v25 row_shr:1 row_mask:0xf bank_mask:0xf
    v_add_f32_dpp v26, v26, v26 row_shr:1 row_mask:0xf bank_mask:0xf
    v_add_f32_dpp v27, v27, v27 row_shr:1 row_mask:0xf bank_mask:0xf
    v_add_f32_dpp v24, v24, v24 row_shr:2 row_mask:0xf bank_mask:0xf
    v_add_f32_dpp v25, v25, v25 row_shr:2 row_mask:0xf bank_mask:0xf
    v_add_f32_dpp v26, v26, v26 row_shr:2 row_mask:0xf bank_mask:0xf
    v_add_f32_dpp v27, v27, v27 row_shr:2 row_mask:0xf bank_mask:0xf
    s_waitcnt lgkmcnt(0)
    global_store_dwordx4 v7, v[40:43], s[58:59] sc1
    global_store_dwordx4 v7, v[44:47], s[58:59] offset:1024 sc1
    v_add_f32_dpp v24, v24, v24 row_shr:4 row_mask:0xf bank_mask:0xf
    v_add_f32_dpp v25, v25, v25 row_shr:4 row_mask:0xf bank_mask:0xf
    v_add_f32_dpp v26, v26, v26 row_shr:4 row_mask:0xf bank_mask:0xf
    v_add_f32_dpp v27, v27, v27 row_shr:4 row_mask:0xf bank_mask:0xf
    v_add_f32_dpp v24, v24, v24 row_shr:8 row_mask:0xf bank_mask:0xf
    v_add_f32_dpp v25, v25, v25 row_shr:8 row_mask:0xf bank_mask:0xf
    v_add_f32_dpp v26, v26, v26 row_shr:8 row_mask:0xf bank_mask:0xf
    v_add_f32_dpp v27, v27, v27 row_shr:8 row_mask:0xf bank_mask:0xf
    v_add_f32_dpp v24, v24, v24 row_bcast:15 row_mask:0xa bank_mask:0xf
    v_add_f32_dpp v25, v25, v25 row_bcast:15 row_mask:0xa bank_mask:0xf
    v_add_f32_dpp v26, v26, v26 row_bcast:15 row_mask:0xa bank_mask:0xf
    v_add_f32_dpp v27, v27, v27 row_bcast:15 row_mask:0xa bank_mask:0xf
    v_add_f32_dpp v24, v24, v24 row_bcast:31 row_mask:0xc bank_mask:0xf
    v_add_f32_dpp v25, v25, v25 row_bcast:31 row_mask:0xc bank_mask:0xf
    v_add_f32_dpp v26, v26, v26 row_bcast:31 row_mask:0xc bank_mask:0xf
    v_add_f32_dpp v27, v27, v27 row_bcast:31 row_mask:0xc bank_mask:0xf
    s_mov_b32 s28, 0x3b000000
    v_mul_f32 v24, s28, v24
    v_mul_f32 v25, s28, v25
    v_mul_f32 v26, s28, v26
    v_mul_f32 v27, s28, v27
    v_fma_f32 v26, -v24, v24, v26
    v_fma_f32 v27, -v25, v25, v27
    v_cvt_pk_bf16_f32 v28, v24, v25
    v_max_f32 v26, 0, v26
    v_max_f32 v27, 0, v27
    v_lshlrev_b32 v24, 16, v28
    v_and_b32 v25, s36, v28
    s_mov_b32 exec_lo, 0
    s_mov_b32 exec_hi, 0x80000000
    ds_write_b64 v31, v[24:25]
    v_cvt_pk_bf16_f32 v29, v26, v27
    v_lshlrev_b32 v26, 16, v29
    v_and_b32 v27, s36, v29
    v_add_f32 v26, 0x3727c5ac, v26
    v_add_f32 v27, 0x3727c5ac, v27
    v_cvt_pk_bf16_f32 v29, v26, v27
    v_lshlrev_b32 v26, 16, v29
    v_and_b32 v27, s36, v29
    v_sqrt_f32 v26, v26
    v_sqrt_f32 v27, v27
    s_nop 0
    v_cvt_pk_bf16_f32 v29, v26, v27
    v_lshlrev_b32 v26, 16, v29
    v_and_b32 v27, s36, v29
    v_rcp_f32 v26, v26
    v_rcp_f32 v27, v27
    s_nop 0
    ds_write_b64 v31, v[26:27] offset:32
    ds_add_rtn_u32 v4, v252, v254 offset:12
    s_waitcnt lgkmcnt(0)
    v_readfirstlane_b32 s28, v4
    s_nop 0
    s_cmp_lg_u32 s28, 3
    s_cbranch_scc1 L_ka_nost
    s_mov_b64 exec, 0xf
    ds_read_b128 v[24:27], v36 offset:64
    s_waitcnt lgkmcnt(0)
    global_store_dwordx4 v30, v[24:27], s[58:59] sc1
L_ka_nost:
    s_mov_b64 exec, -1
    s_lshl_b32 s28, s27, 2
    s_load_dword s41, s[16:17], s28
    v_lshl_add_u32 v249, v244, 1, v245
    v_add_u32 v246, 2719, v249
    v_bfe_u32 v247, v246, 3, 1
    v_xor_b32 v247, s60, v247
    v_lshlrev_b32 v246, 5, v246
    v_lshl_add_u32 v224, v247, 4, v246
    v_add_u32 v246, 2715, v249
    v_bfe_u32 v247, v246, 3, 1
    v_xor_b32 v247, s60, v247
    v_lshlrev_b32 v246, 5, v246
    v_lshl_add_u32 v225, v247, 4, v246
    v_add_u32 v246, 2711, v249
    v_bfe_u32 v247, v246, 3, 1
    v_xor_b32 v247, s60, v247
    v_lshlrev_b32 v246, 5, v246
    v_lshl_add_u32 v226, v247, 4, v246
    v_add_u32 v246, 2707, v249
    v_bfe_u32 v247, v246, 3, 1
    v_xor_b32 v247, s60, v247
    v_lshlrev_b32 v246, 5, v246
    v_lshl_add_u32 v227, v247, 4, v246
    s_lshl_b32 s28, s60, 15
    v_lshl_add_u32 v247, v245, 4, s28
    v_and_b32 v246, 7, v244
    v_mul_u32_u24 v246, 2112, v246
    v_lshrrev_b32 v248, 3, v244
    v_sub_u32 v248, 1, v248
    v_lshl_add_u32 v246, v248, 4, v246
    v_add_u32 v228, v246, v247
    v_and_b32 v246, 1, v244
    v_mul_u32_u24 v246, 8448, v246
    v_lshrrev_b32 v248, 1, v244
    v_sub_u32 v248, 7, v248
    v_lshl_add_u32 v246, v248, 4, v246
    v_add_u32 v229, v246, v247
    v_and_b32 v246, 3, v244
    v_mul_u32_u24 v246, 4224, v246
    v_lshrrev_b32 v248, 2, v244
    v_sub_u32 v248, 3, v248
    v_lshl_add_u32 v246, v248, 4, v246
    v_add_u32 v230, v246, v247
    v_bfe_u32 v246, v1, 2, 2
    v_lshl_add_u32 v246, v245, 3, v246
    v_bfe_u32 v247, v1, 2, 1
    v_and_b32 v248, 3, v1
    s_mul_i32 s28, s60, 10752
    s_add_u32 s28, s28, 96520
    v_lshl_add_u32 v248, v248, 3, s28
    v_mul_u32_u24 v249, 3200, v247
    v_lshl_add_u32 v249, v246, 3, v249
    v_add_u32 v231, v248, v249
    v_mul_u32_u24 v249, 2096, v247
    v_lshl_add_u32 v249, v246, 4, v249
    v_add_u32 v232, v248, v249
    v_and_b32 v247, 1, v245
    v_lshrrev_b32 v248, 1, v245
    v_lshl_add_u32 v246, v244, 1, v248
    v_lshl_add_u32 v249, v247, 5, v246
    s_add_u32 s28, s28, 24
    v_lshl_add_u32 v233, v249, 4, s28
    v_bfe_u32 v249, v244, 2, 1
    v_xor_b32 v249, s60, v249
    v_lshl_add_u32 v249, v246, 1, v249
    v_lshl_add_u32 v249, v249, 1, v247
    s_lshl_b32 s28, s62, 11
    s_add_u32 s28, s28, 88064
    v_lshl_add_u32 v234, v249, 3, s28
    s_and_b32 s30, s27, 2
    v_and_b32 v246, 3, v246
    v_xor_b32 v246, s30, v246
    s_lshl_b32 s28, s27, 7
    s_lshl_b32 s30, s60, 6
    s_add_u32 s28, s28, s30
    s_mul_i32 s30, s62, 528384
    s_add_u32 s28, s28, s30
    s_add_u32 s28, s28, 4718592
    v_lshl_add_u32 v246, v246, 4, s28
    v_lshrrev_b32 v249, 1, v244
    v_lshl_add_u32 v249, v247, 3, v249
    s_mov_b32 s30, 33024
    v_mad_u32_u24 v235, v249, s30, v246
    s_waitcnt lgkmcnt(0)
    s_lshl_b32 s42, s41, 16
    s_and_b32 s41, s41, s36
    s_cmp_eq_u32 s60, 0
    s_cselect_b32 s42, s42, s41
    v_mov_b32 v64, 0
    v_mov_b32 v65, 0
    v_mov_b32 v66, 0
    v_mov_b32 v67, 0
    v_min_u32 v60, 111, v62
    v_cmp_lt_u32 vcc, 95, v60
    v_lshlrev_b32 v60, 4, v60
    v_add_u32 v61, 8192, v60
    v_cndmask_b32 v60, v60, v61, vcc
    v_add_u32 v60, 86528, v60
    ds_write_b128 v60, v[64:67]
    v_and_b32 v60, 1, v0
    v_bfe_u32 v61, v0, 1, 1
    v_mul_u32_u24 v61, 10752, v61
    v_lshl_add_u32 v61, v60, 4, v61
    v_add_u32 v61, 96512, v61
    ds_write_b128 v61, v[64:67] offset:0
    ds_write_b128 v61, v[64:67] offset:3200
    ds_write_b128 v61, v[64:67] offset:6400
    ds_write_b128 v61, v[64:67] offset:8496
    s_mov_b32 s31, 8320
    s_lshl_b32 s29, s27, 5
    v_lshrrev_b32 v61, 1, v62
    v_lshl_add_u32 v60, v60, 4, s29
    v_mad_u32_u24 v236, v61, s31, v60
    v_add_u32 v239, 1064960, v236
    s_lshl_b32 s29, s39, 11
    s_add_u32 s28, s29, 4456448
    v_lshl_add_u32 v237, v1, 4, s28
    v_add_u32 v251, 8192, v237
    s_add_u32 s43, s29, 135680
    v_lshlrev_b32 v243, 6, v61
    v_add_u32 v243, 135680, v243
    v_bfe_u32 v60, v0, 4, 1
    v_xor_b32 v60, v60, v62
    v_lshlrev_b32 v60, 4, v60
    v_add_u32 v238, 88064, v60
    s_bfe_u32 s28, s2, 0x30003
    s_mul_i32 s29, s28, 4096
    s_add_u32 s29, s29, 25231360
    v_and_b32 v60, 15, v1
    v_mul_u32_u24 v240, 256, v60
    v_add_u32 v240, s29, v240
    v_mov_b32 v80, 16
    v_mov_b32 v88, 0
    v_mov_b32 v89, 0
    s_mov_b64 exec, 1
    s_waitcnt vmcnt(0)
    ds_add_rtn_u32 v4, v252, v254
    s_waitcnt lgkmcnt(0)
    v_readfirstlane_b32 s28, v4
    s_nop 0
    s_cmp_lg_u32 s28, 3
    s_cbranch_scc1 L_ka_nosig
    s_setprio 2
    s_mov_b32 s44, 1
    s_mov_b32 s30, 0
    s_mov_b32 s48, 0xff
    s_mov_b32 s49, 0
L_ka_arr:
    s_mov_b64 exec, s[48:49]
    global_atomic_add_x2 v[4:5], v78, v[86:87], s[58:59] sc0 sc1
L_ka_poll:
    s_mov_b32 exec_lo, 0xffff
    global_atomic_add_x2 v[10:11], v240, v[88:89], s[58:59] sc0 sc1
    s_add_u32 s30, s30, 1
    s_waitcnt vmcnt(0)
    v_cmp_ne_u64 vcc, v[80:81], v[10:11]
    s_cmp_lt_u32 s30, 0x100000
    s_mov_b32 exec_lo, 0xff
    v_cmp_ne_u32 s[48:49], v81, v5
    s_cbranch_scc0 L_ka_polled
    s_nop 1
    s_cmp_lg_u64 s[48:49], 0
    s_cbranch_scc1 L_ka_arr
    s_cbranch_vccnz L_ka_poll
L_ka_polled:
    s_mov_b64 exec, 1
    ds_add_u32 v252, v254 offset:4
    s_mov_b64 exec, -1
    s_branch L_ka_gath
L_ka_nosig:
    s_mov_b64 exec, -1
    s_setprio 0
    s_cmp_lg_u32 s28, 0
    s_cbranch_scc1 L_ka_nopoison
    v_mov_b32 v68, -1
    v_mov_b32 v69, -1
    v_mov_b32 v70, -1
    v_mov_b32 v71, -1
    s_lshl_b32 s28, s2, 10
    s_add_u32 s28, s28, 6979584
    v_lshl_add_u32 v72, v1, 4, s28
    global_store_dwordx4 v72, v[68:71], s[58:59] sc1
L_ka_nopoison:
    s_branch L_ka_warm2
L_ka_back2:
    s_branch L_ka_warm3
L_ka_back3:
L_ka_w5:
    s_sleep 1
    ds_read_b32 v255, v252 offset:4
    s_waitcnt lgkmcnt(0)
    v_readfirstlane_b32 s63, v255
    s_nop 0
    s_cmp_lt_u32 s63, 1
    s_cbranch_scc1 L_ka_w5
    s_setprio 2
L_ka_gath:
    s_mov_b32 m0, s43
    global_load_dwordx4 v[172:175], v236, s[58:59] sc1
    global_load_lds_dwordx4 v237, s[58:59] sc1
    global_load_lds_dwordx4 v237, s[58:59] offset:1024 sc1
    s_add_u32 m0, s43, 8192
    global_load_dwordx4 v[176:179], v239, s[58:59] sc1
    global_load_lds_dwordx4 v251, s[58:59] sc1
    global_load_lds_dwordx4 v251, s[58:59] offset:1024 sc1
L_ka_w6:
    ds_read_b32 v255, v253 offset:8
    s_waitcnt lgkmcnt(0)
    v_readfirstlane_b32 s63, v255
    s_nop 0
    s_cmp_lt_u32 s63, 2
    s_cbranch_scc1 L_ka_w6
    ds_read_b128 v[32:35], v228 offset:1024
    ds_read_b128 v[36:39], v228 offset:960
    ds_read_b128 v[40:43], v228 offset:896
    ds_read_b128 v[44:47], v228 offset:832
    ds_read_b128 v[48:51], v228 offset:768
    ds_read_b128 v[52:55], v228 offset:704
    ds_read_b128 v[56:59], v228 offset:640
    ds_read_b128 v[60:63], v228 offset:576
    ds_read_b128 v[64:67], v228 offset:512
    ds_read_b128 v[68:71], v228 offset:448
    ds_read_b128 v[72:75], v228 offset:384
    ds_read_b128 v[76:79], v228 offset:320
    ds_read_b128 v[80:83], v228 offset:256
    ds_read_b128 v[84:87], v228 offset:192
    ds_read_b128 v[88:91], v228 offset:128
    ds_read_b128 v[92:95], v228 offset:64
    ds_read_b128 v[96:99], v228 offset:0
    ds_read_b128 v[100:103], v228 offset:1120
    ds_read_b128 v[104:107], v229 offset:5760
    ds_read_b128 v[108:111], v229 offset:5696
    ds_read_b128 v[112:115], v229 offset:5632
    ds_read_b128 v[116:119], v229 offset:5568
    ds_read_b128 v[120:123], v229 offset:5504
    ds_read_b128 v[124:127], v229 offset:5440
    ds_read_b128 v[128:131], v230 offset:1920
    ds_read_b128 v[132:135], v230 offset:1856
    ds_read_b128 v[136:139], v230 offset:1792
    ds_read_b128 v[140:143], v230 offset:1728
    s_waitcnt vmcnt(3)
    ds_read_b128 v[180:183], v243 offset:0
    ds_read_b128 v[184:187], v243 offset:16
    ds_read_b128 v[188:191], v243 offset:32
    ds_read_b128 v[192:195], v243 offset:48
    ds_write_b128 v238, v[172:175] offset:29952
    v_lshlrev_b32 v2, 16, v172
    v_and_b32 v3, s36, v172
    v_lshlrev_b32 v4, 16, v173
    v_and_b32 v5, s36, v173
    v_lshlrev_b32 v6, 16, v174
    v_and_b32 v7, s36, v174
    v_lshlrev_b32 v8, 16, v175
    v_and_b32 v9, s36, v175
    s_waitcnt lgkmcnt(1)
    v_pk_add_f32 v[2:3], v[2:3], v[180:181] neg_lo:[0,1] neg_hi:[0,1]
    v_pk_add_f32 v[4:5], v[4:5], v[182:183] neg_lo:[0,1] neg_hi:[0,1]
    v_pk_add_f32 v[6:7], v[6:7], v[184:185] neg_lo:[0,1] neg_hi:[0,1]
    v_pk_add_f32 v[8:9], v[8:9], v[186:187] neg_lo:[0,1] neg_hi:[0,1]
    v_cvt_pk_bf16_f32 v10, v2, v3
    v_cvt_pk_bf16_f32 v11, v4, v5
    v_cvt_pk_bf16_f32 v12, v6, v7
    v_cvt_pk_bf16_f32 v13, v8, v9
    v_lshlrev_b32 v2, 16, v10
    v_and_b32 v3, s36, v10
    v_lshlrev_b32 v4, 16, v11
    v_and_b32 v5, s36, v11
    v_lshlrev_b32 v6, 16, v12
    v_and_b32 v7, s36, v12
    v_lshlrev_b32 v8, 16, v13
    v_and_b32 v9, s36, v13
    v_pk_mul_f32 v[2:3], v[2:3], v[188:189]
    v_pk_mul_f32 v[4:5], v[4:5], v[190:191]
    v_pk_mul_f32 v[6:7], v[6:7], v[192:193]
    v_pk_mul_f32 v[8:9], v[8:9], v[194:195]
    v_cvt_pk_bf16_f32 v10, v2, v3
    v_cvt_pk_bf16_f32 v11, v4, v5
    v_cvt_pk_bf16_f32 v12, v6, v7
    v_cvt_pk_bf16_f32 v13, v8, v9
    ds_write_b128 v238, v[10:13] offset:0
    s_waitcnt vmcnt(0)
    ds_read_b128 v[196:199], v243 offset:8192
    ds_read_b128 v[200:203], v243 offset:8208
    ds_read_b128 v[204:207], v243 offset:8224
    ds_read_b128 v[208:211], v243 offset:8240
    s_mov_b64 exec, 1
    ds_add_u32 v252, v254 offset:8
    s_mov_b64 exec, -1
    ds_write_b128 v238, v[176:179] offset:34048
    v_lshlrev_b32 v14, 16, v176
    v_and_b32 v15, s36, v176
    v_lshlrev_b32 v16, 16, v177
    v_and_b32 v17, s36, v177
    v_lshlrev_b32 v18, 16, v178
    v_and_b32 v19, s36, v178
    v_lshlrev_b32 v20, 16, v179
    v_and_b32 v21, s36, v179
    s_waitcnt lgkmcnt(2)
    v_pk_add_f32 v[14:15], v[14:15], v[196:197] neg_lo:[0,1] neg_hi:[0,1]
    v_pk_add_f32 v[16:17], v[16:17], v[198:199] neg_lo:[0,1] neg_hi:[0,1]
    v_pk_add_f32 v[18:19], v[18:19], v[200:201] neg_lo:[0,1] neg_hi:[0,1]
    v_pk_add_f32 v[20:21], v[20:21], v[202:203] neg_lo:[0,1] neg_hi:[0,1]
    v_cvt_pk_bf16_f32 v22, v14, v15
    v_cvt_pk_bf16_f32 v23, v16, v17
    v_cvt_pk_bf16_f32 v24, v18, v19
    v_cvt_pk_bf16_f32 v25, v20, v21
    v_lshlrev_b32 v14, 16, v22
    v_and_b32 v15, s36, v22
    v_lshlrev_b32 v16, 16, v23
    v_and_b32 v17, s36, v23
    v_lshlrev_b32 v18, 16, v24
    v_and_b32 v19, s36, v24
    v_lshlrev_b32 v20, 16, v25
    v_and_b32 v21, s36, v25
    v_pk_mul_f32 v[14:15], v[14:15], v[204:205]
    v_pk_mul_f32 v[16:17], v[16:17], v[206:207]
    v_pk_mul_f32 v[18:19], v[18:19], v[208:209]
    v_pk_mul_f32 v[20:21], v[20:21], v[210:211]
    v_cvt_pk_bf16_f32 v22, v14, v15
    v_cvt_pk_bf16_f32 v23, v16, v17
    v_cvt_pk_bf16_f32 v24, v18, v19
    v_cvt_pk_bf16_f32 v25, v20, v21
    ds_write_b128 v238, v[22:25] offset:4096
    s_setprio 0
    s_cmp_eq_u32 s61, 0
    s_cbranch_scc1 L_ka_r2
    s_setprio 0
    s_waitcnt lgkmcnt(0)
    s_barrier
    ds_read_b128 v[172:175], v224 offset:6144
    ds_read_b128 v[176:179], v227 offset:6656
    ds_read_b128 v[180:183], v226 offset:6656
    s_waitcnt lgkmcnt(2)
    v_mfma_f32_16x16x32_bf16 v[144:147], v[64:67], v[172:175], 0
    ds_read_b128 v[184:187], v225 offset:6656
    ds_read_b128 v[188:191], v224 offset:6656
    v_mfma_f32_16x16x32_bf16 v[148:151], v[96:99], v[172:175], 0
    ds_read_b128 v[192:195], v227 offset:7168
    s_waitcnt lgkmcnt(4)
    v_mfma_f32_16x16x32_bf16 v[144:147], v[60:63], v[176:179], v[144:147]
    ds_read_b128 v[196:199], v226 offset:7168
    v_mfma_f32_16x16x32_bf16 v[148:151], v[92:95], v[176:179], v[148:151]
    ds_read_b128 v[200:203], v225 offset:7168
    s_waitcnt lgkmcnt(5)
    v_mfma_f32_16x16x32_bf16 v[144:147], v[56:59], v[180:183], v[144:147]
    ds_read_b128 v[204:207], v224 offset:7168
    ds_read_b128 v[208:211], v224 offset:5120
    v_mfma_f32_16x16x32_bf16 v[148:151], v[88:91], v[180:183], v[148:151]
    ds_read_b128 v[172:175], v227 offset:7680
    s_waitcnt lgkmcnt(7)
    v_mfma_f32_16x16x32_bf16 v[144:147], v[52:55], v[184:187], v[144:147]
    ds_read_b128 v[176:179], v227 offset:5632
    v_mfma_f32_16x16x32_bf16 v[148:151], v[84:87], v[184:187], v[148:151]
    s_waitcnt lgkmcnt(7)
    v_mfma_f32_16x16x32_bf16 v[144:147], v[48:51], v[188:191], v[144:147]
    ds_read_b128 v[180:183], v226 offset:7680
    ds_read_b64 v[156:157], v234 offset:0
    ds_read_b64 v[158:159], v234 offset:29952
    ds_read_b64 v[164:165], v234 offset:1024
    ds_read_b64 v[166:167], v234 offset:30976
    v_mfma_f32_16x16x32_bf16 v[148:151], v[80:83], v[188:191], v[148:151]
    s_waitcnt lgkmcnt(11)
    v_mfma_f32_16x16x32_bf16 v[144:147], v[44:47], v[192:195], v[144:147]
    ds_read_b128 v[184:187], v226 offset:5632
    v_mfma_f32_16x16x32_bf16 v[148:151], v[76:79], v[192:195], v[148:151]
    s_waitcnt lgkmcnt(11)
    v_mfma_f32_16x16x32_bf16 v[144:147], v[40:43], v[196:199], v[144:147]
    ds_read_b128 v[188:191], v225 offset:7680
    v_mfma_f32_16x16x32_bf16 v[148:151], v[72:75], v[196:199], v[148:151]
    s_waitcnt lgkmcnt(11)
    v_mfma_f32_16x16x32_bf16 v[144:147], v[36:39], v[200:203], v[144:147]
    ds_read_b128 v[192:195], v225 offset:5632
    s_waitcnt lgkmcnt(3)
    v_lshlrev_b32 v152, 16, v156
    v_and_b32 v153, s36, v156
    v_mfma_f32_16x16x32_bf16 v[148:151], v[68:71], v[200:203], v[148:151]
    v_lshlrev_b32 v154, 16, v157
    v_and_b32 v155, s36, v157
    v_mfma_f32_16x16x32_bf16 v[144:147], v[32:35], v[204:207], v[144:147]
    ds_read_b128 v[196:199], v224 offset:7680
    v_mul_f32 v152, s42, v152
    v_mul_f32 v153, s42, v153
    v_mfma_f32_16x16x32_bf16 v[148:151], v[64:67], v[204:207], v[148:151]
    v_mul_f32 v154, s42, v154
    v_mul_f32 v155, s42, v155
    v_mfma_f32_16x16x32_bf16 v[144:147], v[96:99], v[208:211], v[144:147]
    ds_read_b128 v[200:203], v224 offset:5632
    v_cvt_pk_bf16_f32 v153, v152, v153
    v_cvt_pk_bf16_f32 v155, v154, v155
    v_mfma_f32_16x16x32_bf16 v[148:151], v[60:63], v[172:175], v[148:151]
    ds_read_b128 v[204:207], v227 offset:8192
    v_lshlrev_b32 v152, 16, v153
    v_and_b32 v153, s36, v153
    v_mfma_f32_16x16x32_bf16 v[144:147], v[92:95], v[176:179], v[144:147]
    ds_read_b128 v[208:211], v227 offset:6144
    v_lshlrev_b32 v154, 16, v155
    v_and_b32 v155, s36, v155
    v_mfma_f32_16x16x32_bf16 v[148:151], v[56:59], v[180:183], v[148:151]
    ds_read_b128 v[172:175], v226 offset:8192
    v_lshlrev_b32 v156, 16, v158
    v_and_b32 v157, s36, v158
    s_waitcnt lgkmcnt(7)
    v_mfma_f32_16x16x32_bf16 v[144:147], v[88:91], v[184:187], v[144:147]
    ds_read_b128 v[176:179], v226 offset:6144
    v_lshlrev_b32 v158, 16, v159
    v_and_b32 v159, s36, v159
    s_waitcnt lgkmcnt(7)
    v_mfma_f32_16x16x32_bf16 v[148:151], v[52:55], v[188:191], v[148:151]
    ds_read_b128 v[180:183], v225 offset:8192
    v_lshlrev_b32 v160, 16, v164
    v_and_b32 v161, s36, v164
    s_waitcnt lgkmcnt(7)
    v_mfma_f32_16x16x32_bf16 v[144:147], v[84:87], v[192:195], v[144:147]
    ds_read_b128 v[184:187], v225 offset:6144
    v_lshlrev_b32 v162, 16, v165
    v_and_b32 v163, s36, v165
    s_waitcnt lgkmcnt(7)
    v_mfma_f32_16x16x32_bf16 v[148:151], v[48:51], v[196:199], v[148:151]
    ds_read_b128 v[188:191], v224 offset:8192
    v_mul_f32 v160, s42, v160
    v_mul_f32 v161, s42, v161
    s_waitcnt lgkmcnt(7)
    v_mfma_f32_16x16x32_bf16 v[144:147], v[80:83], v[200:203], v[144:147]
    ds_read_b128 v[192:195], v224 offset:3072
    v_mul_f32 v162, s42, v162
    v_mul_f32 v163, s42, v163
    s_waitcnt lgkmcnt(7)
    v_mfma_f32_16x16x32_bf16 v[148:151], v[44:47], v[204:207], v[148:151]
    ds_read_b128 v[196:199], v224 offset:4096
    v_cvt_pk_bf16_f32 v161, v160, v161
    v_cvt_pk_bf16_f32 v163, v162, v163
    s_waitcnt lgkmcnt(7)
    v_mfma_f32_16x16x32_bf16 v[144:147], v[76:79], v[208:211], v[144:147]
L_ka_w7:
    ds_read_b32 v255, v253 offset:12
    s_waitcnt lgkmcnt(0)
    v_readfirstlane_b32 s63, v255
    s_nop 0
    s_cmp_lt_u32 s63, 1
    s_cbranch_scc1 L_ka_w7
    ds_read_b64_tr_b16 v[200:201], v232 offset:6400
    ds_read_b64_tr_b16 v[202:203], v232 offset:6464
    v_lshlrev_b32 v160, 16, v161
    v_and_b32 v161, s36, v161
    v_mfma_f32_16x16x32_bf16 v[148:151], v[40:43], v[172:175], v[148:151]
    ds_read_b64_tr_b16 v[204:205], v232 offset:6912
    ds_read_b64_tr_b16 v[206:207], v232 offset:6976
    v_lshlrev_b32 v162, 16, v163
    v_and_b32 v163, s36, v163
    v_mfma_f32_16x16x32_bf16 v[144:147], v[72:75], v[176:179], v[144:147]
    ds_read_b64_tr_b16 v[208:209], v232 offset:7424
    ds_read_b64_tr_b16 v[210:211], v232 offset:7488
    v_lshlrev_b32 v164, 16, v166
    v_and_b32 v165, s36, v166
    v_mfma_f32_16x16x32_bf16 v[148:151], v[36:39], v[180:183], v[148:151]
    ds_read_b64_tr_b16 v[172:173], v232 offset:7936
    ds_read_b64_tr_b16 v[174:175], v232 offset:8000
    v_lshlrev_b32 v166, 16, v167
    v_and_b32 v167, s36, v167
    v_mfma_f32_16x16x32_bf16 v[144:147], v[68:71], v[184:187], v[144:147]
    ds_read_b64_tr_b16 v[176:177], v231 offset:1024
    ds_read_b64_tr_b16 v[178:179], v231 offset:1056
    v_mfma_f32_16x16x32_bf16 v[148:151], v[32:35], v[188:191], v[148:151]
    ds_read_b64_tr_b16 v[180:181], v231 offset:1280
    ds_read_b64_tr_b16 v[182:183], v231 offset:1312
    v_mfma_f32_16x16x32_bf16 v[144:147], v[100:103], v[192:195], v[144:147]
    ds_read_b64_tr_b16 v[184:185], v231 offset:1536
    ds_read_b64_tr_b16 v[186:187], v231 offset:1568
    v_mfma_f32_16x16x32_bf16 v[148:151], v[100:103], v[196:199], v[148:151]
    ds_read_b64_tr_b16 v[188:189], v231 offset:1792
    ds_read_b64_tr_b16 v[190:191], v231 offset:1824
    s_waitcnt lgkmcnt(14)
    v_mfma_f32_16x16x32_bf16 v[144:147], v[200:203], v[136:139], v[144:147]
    ds_read_b64_tr_b16 v[192:193], v231 offset:2048
    ds_read_b64_tr_b16 v[194:195], v231 offset:2080
    v_mfma_f32_16x16x32_bf16 v[148:151], v[200:203], v[140:143], v[148:151]
    s_waitcnt lgkmcnt(14)
    v_mfma_f32_16x16x32_bf16 v[144:147], v[204:207], v[132:135], v[144:147]
    ds_read_b64_tr_b16 v[196:197], v231 offset:2304
    ds_read_b64_tr_b16 v[198:199], v231 offset:2336
    v_mfma_f32_16x16x32_bf16 v[148:151], v[204:207], v[136:139], v[148:151]
    s_waitcnt lgkmcnt(14)
    v_mfma_f32_16x16x32_bf16 v[144:147], v[208:211], v[128:131], v[144:147]
    ds_read_b64_tr_b16 v[200:201], v231 offset:2560
    ds_read_b64_tr_b16 v[202:203], v231 offset:2592
    v_mfma_f32_16x16x32_bf16 v[148:151], v[208:211], v[132:135], v[148:151]
    s_waitcnt lgkmcnt(14)
    v_mfma_f32_16x16x32_bf16 v[148:151], v[172:175], v[128:131], v[148:151]
    ds_read_b64_tr_b16 v[204:205], v231 offset:2816
    ds_read_b64_tr_b16 v[206:207], v231 offset:2848
    s_waitcnt lgkmcnt(14)
    v_mfma_f32_16x16x32_bf16 v[144:147], v[176:179], v[124:127], v[144:147]
    s_waitcnt lgkmcnt(12)
    v_mfma_f32_16x16x32_bf16 v[144:147], v[180:183], v[120:123], v[144:147]
    s_waitcnt lgkmcnt(10)
    v_mfma_f32_16x16x32_bf16 v[144:147], v[184:187], v[116:119], v[144:147]
    v_mfma_f32_16x16x32_bf16 v[148:151], v[184:187], v[124:127], v[148:151]
    s_waitcnt lgkmcnt(8)
    v_mfma_f32_16x16x32_bf16 v[144:147], v[188:191], v[112:115], v[144:147]
    v_mfma_f32_16x16x32_bf16 v[148:151], v[188:191], v[120:123], v[148:151]
    s_waitcnt lgkmcnt(6)
    v_mfma_f32_16x16x32_bf16 v[144:147], v[192:195], v[108:111], v[144:147]
    v_mfma_f32_16x16x32_bf16 v[148:151], v[192:195], v[116:119], v[148:151]
    s_waitcnt lgkmcnt(4)
    v_mfma_f32_16x16x32_bf16 v[144:147], v[196:199], v[104:107], v[144:147]
    v_mfma_f32_16x16x32_bf16 v[148:151], v[196:199], v[112:115], v[148:151]
    s_waitcnt lgkmcnt(2)
    v_mfma_f32_16x16x32_bf16 v[148:151], v[200:203], v[108:111], v[148:151]
    s_waitcnt lgkmcnt(0)
    v_mfma_f32_16x16x32_bf16 v[148:151], v[204:207], v[104:107], v[148:151]
    s_branch L_ka_epi
.p2align 6
L_ka_warm0:
    s_branch L_ka_back0
L_ka_r0:
    s_setprio 2
    s_waitcnt lgkmcnt(0)
    s_barrier
    ds_read_b128 v[172:175], v224 offset:1024
    ds_read_b128 v[176:179], v224 offset:2048
    ds_read_b128 v[180:183], v224 offset:3072
    ds_read_b128 v[184:187], v224 offset:4096
    ds_read_b128 v[188:191], v224 offset:5120
    ds_read_b128 v[192:195], v224 offset:6144
    s_waitcnt lgkmcnt(4)
    v_mfma_f32_16x16x32_bf16 v[2:5], v[152:155], v[172:175], 0
    v_mfma_f32_16x16x32_bf16 v[6:9], v[152:155], v[176:179], 0
    v_mfma_f32_16x16x32_bf16 v[10:13], v[156:159], v[172:175], 0
    v_mfma_f32_16x16x32_bf16 v[14:17], v[156:159], v[176:179], 0
    v_mfma_f32_16x16x32_bf16 v[18:21], v[160:163], v[172:175], 0
    v_mfma_f32_16x16x32_bf16 v[22:25], v[160:163], v[176:179], 0
    s_nop 2
    v_cvt_pk_bf16_f32 v2, v2, v3
    v_cvt_pk_bf16_f32 v3, v4, v5
    v_cvt_pk_bf16_f32 v4, v6, v7
    v_cvt_pk_bf16_f32 v5, v8, v9
    s_nop 0
    v_permlane16_swap_b32 v2, v4
    v_permlane16_swap_b32 v3, v5
    ds_write_b128 v233, v[2:5] offset:0
    v_mfma_f32_16x16x32_bf16 v[204:207], v[164:167], v[172:175], 0
    v_mfma_f32_16x16x32_bf16 v[208:211], v[164:167], v[176:179], 0
    v_cvt_pk_bf16_f32 v10, v10, v11
    v_cvt_pk_bf16_f32 v11, v12, v13
    v_cvt_pk_bf16_f32 v12, v14, v15
    v_cvt_pk_bf16_f32 v13, v16, v17
    s_nop 0
    v_permlane16_swap_b32 v10, v12
    v_permlane16_swap_b32 v11, v13
    ds_write_b128 v233, v[10:13] offset:3200
    s_waitcnt lgkmcnt(4)
    v_mfma_f32_16x16x32_bf16 v[2:5], v[152:155], v[180:183], 0
    v_mfma_f32_16x16x32_bf16 v[6:9], v[152:155], v[184:187], 0
    v_cvt_pk_bf16_f32 v18, v18, v19
    v_cvt_pk_bf16_f32 v19, v20, v21
    v_cvt_pk_bf16_f32 v20, v22, v23
    v_cvt_pk_bf16_f32 v21, v24, v25
    s_nop 0
    v_permlane16_swap_b32 v18, v20
    v_permlane16_swap_b32 v19, v21
    ds_write_b128 v233, v[18:21] offset:6400
    v_mfma_f32_16x16x32_bf16 v[10:13], v[156:159], v[180:183], 0
    v_mfma_f32_16x16x32_bf16 v[14:17], v[156:159], v[184:187], 0
    v_cvt_pk_bf16_f32 v204, v204, v205
    v_cvt_pk_bf16_f32 v205, v206, v207
    v_cvt_pk_bf16_f32 v206, v208, v209
    v_cvt_pk_bf16_f32 v207, v210, v211
    s_nop 0
    v_permlane16_swap_b32 v204, v206
    v_permlane16_swap_b32 v205, v207
    ds_write_b128 v233, v[204:207] offset:8496
    v_mfma_f32_16x16x32_bf16 v[18:21], v[160:163], v[180:183], 0
    v_mfma_f32_16x16x32_bf16 v[22:25], v[160:163], v[184:187], 0
    v_cvt_pk_bf16_f32 v2, v2, v3
    v_cvt_pk_bf16_f32 v3, v4, v5
    v_cvt_pk_bf16_f32 v4, v6, v7
    v_cvt_pk_bf16_f32 v5, v8, v9
    s_nop 0
    v_permlane16_swap_b32 v2, v4
    v_permlane16_swap_b32 v3, v5
    ds_write_b128 v233, v[2:5] offset:1024
    v_mfma_f32_16x16x32_bf16 v[204:207], v[164:167], v[180:183], 0
    v_mfma_f32_16x16x32_bf16 v[208:211], v[164:167], v[184:187], 0
    v_cvt_pk_bf16_f32 v10, v10, v11
    v_cvt_pk_bf16_f32 v11, v12, v13
    v_cvt_pk_bf16_f32 v12, v14, v15
    v_cvt_pk_bf16_f32 v13, v16, v17
    s_nop 0
    v_permlane16_swap_b32 v10, v12
    v_permlane16_swap_b32 v11, v13
    ds_write_b128 v233, v[10:13] offset:4224
    s_waitcnt lgkmcnt(6)
    v_mfma_f32_16x16x32_bf16 v[2:5], v[152:155], v[188:191], 0
    v_mfma_f32_16x16x32_bf16 v[6:9], v[152:155], v[192:195], 0
    v_cvt_pk_bf16_f32 v18, v18, v19
    v_cvt_pk_bf16_f32 v19, v20, v21
    v_cvt_pk_bf16_f32 v20, v22, v23
    v_cvt_pk_bf16_f32 v21, v24, v25
    s_nop 0
    v_permlane16_swap_b32 v18, v20
    v_permlane16_swap_b32 v19, v21
    ds_write_b128 v233, v[18:21] offset:7424
    v_mfma_f32_16x16x32_bf16 v[10:13], v[156:159], v[188:191], 0
    v_mfma_f32_16x16x32_bf16 v[14:17], v[156:159], v[192:195], 0
    v_cvt_pk_bf16_f32 v204, v204, v205
    v_cvt_pk_bf16_f32 v205, v206, v207
    v_cvt_pk_bf16_f32 v206, v208, v209
    v_cvt_pk_bf16_f32 v207, v210, v211
    s_nop 0
    v_permlane16_swap_b32 v204, v206
    v_permlane16_swap_b32 v205, v207
    ds_write_b128 v233, v[204:207] offset:9520
    v_cvt_pk_bf16_f32 v2, v2, v3
    v_cvt_pk_bf16_f32 v3, v4, v5
    v_cvt_pk_bf16_f32 v4, v6, v7
    v_cvt_pk_bf16_f32 v5, v8, v9
    s_nop 0
    v_permlane16_swap_b32 v2, v4
    v_permlane16_swap_b32 v3, v5
    ds_write_b128 v233, v[2:5] offset:2048
    v_cvt_pk_bf16_f32 v10, v10, v11
    v_cvt_pk_bf16_f32 v11, v12, v13
    v_cvt_pk_bf16_f32 v12, v14, v15
    v_cvt_pk_bf16_f32 v13, v16, v17
    s_nop 0
    v_permlane16_swap_b32 v10, v12
    v_permlane16_swap_b32 v11, v13
    ds_write_b128 v233, v[10:13] offset:5248
    s_mov_b64 exec, 1
    ds_add_u32 v253, v254 offset:12
    s_mov_b64 exec, -1
    s_setprio 2
    ds_read_b128 v[196:199], v224 offset:0
    ds_read_b128 v[200:203], v227 offset:512
    ds_read_b128 v[204:207], v226 offset:512
    s_waitcnt lgkmcnt(2)
    v_mfma_f32_16x16x32_bf16 v[144:147], v[64:67], v[196:199], 0
    ds_read_b128 v[208:211], v225 offset:512
    ds_read_b128 v[172:175], v224 offset:512
    s_add_u32 m0, s19, 0
    s_nop 0
    buffer_load_dwordx4 v212, s[8:11], s17 offen offset:0 lds
    v_mfma_f32_16x16x32_bf16 v[148:151], v[96:99], v[196:199], 0
    ds_read_b128 v[176:179], v227 offset:1024
    buffer_load_dwordx4 v213, s[8:11], s17 offen offset:1024 lds
    s_waitcnt lgkmcnt(4)
    v_mfma_f32_16x16x32_bf16 v[144:147], v[60:63], v[200:203], v[144:147]
    ds_read_b128 v[180:183], v226 offset:1024
    ds_read_b64 v[156:157], v234 offset:0
    ds_read_b64 v[158:159], v234 offset:29952
    ds_read_b64 v[164:165], v234 offset:1024
    ds_read_b64 v[166:167], v234 offset:30976
    buffer_load_dwordx4 v214, s[8:11], s17 offen offset:2048 lds
    v_mfma_f32_16x16x32_bf16 v[148:151], v[92:95], v[200:203], v[148:151]
    ds_read_b128 v[184:187], v225 offset:1024
    buffer_load_dwordx4 v215, s[8:11], s17 offen offset:3072 lds
    s_waitcnt lgkmcnt(9)
    v_mfma_f32_16x16x32_bf16 v[144:147], v[56:59], v[204:207], v[144:147]
    ds_read_b128 v[188:191], v224 offset:1024
    ds_read_b128 v[192:195], v227 offset:1536
    s_add_u32 m0, s19, 4096
    s_nop 0
    buffer_load_dwordx4 v216, s[8:11], s17 offen offset:0 lds
    v_mfma_f32_16x16x32_bf16 v[148:151], v[88:91], v[204:207], v[148:151]
    ds_read_b128 v[196:199], v226 offset:1536
    buffer_load_dwordx4 v217, s[8:11], s17 offen offset:1024 lds
    s_waitcnt lgkmcnt(11)
    v_mfma_f32_16x16x32_bf16 v[144:147], v[52:55], v[208:211], v[144:147]
    ds_read_b128 v[200:203], v225 offset:1536
    buffer_load_dwordx4 v218, s[8:11], s17 offen offset:2048 lds
    s_add_u32 s17, s17, 229376
    v_mfma_f32_16x16x32_bf16 v[148:151], v[84:87], v[208:211], v[148:151]
    s_add_u32 m0, s19, 28704
    s_nop 0
    buffer_load_dwordx4 v212, s[8:11], s17 offen offset:0 lds
    s_waitcnt lgkmcnt(11)
    v_mfma_f32_16x16x32_bf16 v[144:147], v[48:51], v[172:175], v[144:147]
    ds_read_b128 v[204:207], v224 offset:1536
    s_waitcnt lgkmcnt(6)
    v_lshlrev_b32 v152, 16, v156
    v_and_b32 v153, s36, v156
    buffer_load_dwordx4 v213, s[8:11], s17 offen offset:1024 lds
    v_mfma_f32_16x16x32_bf16 v[148:151], v[80:83], v[172:175], v[148:151]
    v_lshlrev_b32 v154, 16, v157
    v_and_b32 v155, s36, v157
    buffer_load_dwordx4 v214, s[8:11], s17 offen offset:2048 lds
    v_mfma_f32_16x16x32_bf16 v[144:147], v[44:47], v[176:179], v[144:147]
    ds_read_b128 v[208:211], v227 offset:2048
    v_mul_f32 v152, s42, v152
    v_mul_f32 v153, s42, v153
    buffer_load_dwordx4 v215, s[8:11], s17 offen offset:3072 lds
    v_mfma_f32_16x16x32_bf16 v[148:151], v[76:79], v[176:179], v[148:151]
    v_mul_f32 v154, s42, v154
    v_mul_f32 v155, s42, v155
    s_add_u32 m0, s19, 32800
    s_nop 0
    buffer_load_dwordx4 v216, s[8:11], s17 offen offset:0 lds
    v_mfma_f32_16x16x32_bf16 v[144:147], v[40:43], v[180:183], v[144:147]
    ds_read_b128 v[172:175], v226 offset:2048
    v_cvt_pk_bf16_f32 v153, v152, v153
    v_cvt_pk_bf16_f32 v155, v154, v155
    buffer_load_dwordx4 v217, s[8:11], s17 offen offset:1024 lds
    v_mfma_f32_16x16x32_bf16 v[148:151], v[72:75], v[180:183], v[148:151]
    v_lshlrev_b32 v152, 16, v153
    v_and_b32 v153, s36, v153
    buffer_load_dwordx4 v218, s[8:11], s17 offen offset:2048 lds
    s_add_u32 s17, s17, 229376
    s_waitcnt lgkmcnt(7)
    v_mfma_f32_16x16x32_bf16 v[144:147], v[36:39], v[184:187], v[144:147]
    ds_read_b128 v[176:179], v225 offset:2048
    v_lshlrev_b32 v154, 16, v155
    v_and_b32 v155, s36, v155
    v_mfma_f32_16x16x32_bf16 v[148:151], v[68:71], v[184:187], v[148:151]
    v_lshlrev_b32 v156, 16, v158
    v_and_b32 v157, s36, v158
    s_waitcnt lgkmcnt(7)
    v_mfma_f32_16x16x32_bf16 v[144:147], v[32:35], v[188:191], v[144:147]
    ds_read_b128 v[180:183], v224 offset:2048
    v_lshlrev_b32 v158, 16, v159
    v_and_b32 v159, s36, v159
    v_mfma_f32_16x16x32_bf16 v[148:151], v[64:67], v[188:191], v[148:151]
    v_lshlrev_b32 v160, 16, v164
    v_and_b32 v161, s36, v164
    s_waitcnt lgkmcnt(7)
    v_mfma_f32_16x16x32_bf16 v[148:151], v[60:63], v[192:195], v[148:151]
    v_lshlrev_b32 v162, 16, v165
    v_and_b32 v163, s36, v165
    s_waitcnt lgkmcnt(6)
    v_mfma_f32_16x16x32_bf16 v[148:151], v[56:59], v[196:199], v[148:151]
    v_mul_f32 v160, s42, v160
    v_mul_f32 v161, s42, v161
    s_waitcnt lgkmcnt(5)
    v_mfma_f32_16x16x32_bf16 v[148:151], v[52:55], v[200:203], v[148:151]
    v_mul_f32 v162, s42, v162
    v_mul_f32 v163, s42, v163
    s_waitcnt lgkmcnt(4)
    v_mfma_f32_16x16x32_bf16 v[148:151], v[48:51], v[204:207], v[148:151]
    v_cvt_pk_bf16_f32 v161, v160, v161
    v_cvt_pk_bf16_f32 v163, v162, v163
    s_waitcnt lgkmcnt(3)
    v_mfma_f32_16x16x32_bf16 v[148:151], v[44:47], v[208:211], v[148:151]
    v_lshlrev_b32 v160, 16, v161
    v_and_b32 v161, s36, v161
    s_waitcnt lgkmcnt(2)
    v_mfma_f32_16x16x32_bf16 v[148:151], v[40:43], v[172:175], v[148:151]
    v_lshlrev_b32 v162, 16, v163
    v_and_b32 v163, s36, v163
    s_waitcnt lgkmcnt(1)
    v_mfma_f32_16x16x32_bf16 v[148:151], v[36:39], v[176:179], v[148:151]
    v_lshlrev_b32 v164, 16, v166
    v_and_b32 v165, s36, v166
    s_waitcnt lgkmcnt(0)
    v_mfma_f32_16x16x32_bf16 v[148:151], v[32:35], v[180:183], v[148:151]
    v_lshlrev_b32 v166, 16, v167
    v_and_b32 v167, s36, v167
    s_branch L_ka_epi
.p2align 6
L_ka_warm1:
    s_branch L_ka_back1
L_ka_r1:
    s_setprio 2
    s_waitcnt lgkmcnt(0)
    s_barrier
    ds_read_b128 v[172:175], v224 offset:2048
    ds_read_b128 v[176:179], v227 offset:2560
    ds_read_b128 v[180:183], v226 offset:2560
    s_waitcnt lgkmcnt(2)
    v_mfma_f32_16x16x32_bf16 v[144:147], v[64:67], v[172:175], 0
    ds_read_b128 v[184:187], v225 offset:2560
    ds_read_b128 v[188:191], v224 offset:2560
    s_add_u32 m0, s19, 0
    s_nop 0
    buffer_load_dwordx4 v212, s[8:11], s17 offen offset:0 lds
    v_mfma_f32_16x16x32_bf16 v[148:151], v[96:99], v[172:175], 0
    ds_read_b128 v[192:195], v227 offset:3072
    s_waitcnt lgkmcnt(4)
    v_mfma_f32_16x16x32_bf16 v[144:147], v[60:63], v[176:179], v[144:147]
    ds_read_b128 v[196:199], v226 offset:3072
    buffer_load_dwordx4 v213, s[8:11], s17 offen offset:1024 lds
    v_mfma_f32_16x16x32_bf16 v[148:151], v[92:95], v[176:179], v[148:151]
    ds_read_b128 v[200:203], v225 offset:3072
    s_waitcnt lgkmcnt(5)
    v_mfma_f32_16x16x32_bf16 v[144:147], v[56:59], v[180:183], v[144:147]
    ds_read_b128 v[204:207], v224 offset:3072
    ds_read_b128 v[208:211], v224 offset:1024
    buffer_load_dwordx4 v214, s[8:11], s17 offen offset:2048 lds
    v_mfma_f32_16x16x32_bf16 v[148:151], v[88:91], v[180:183], v[148:151]
    ds_read_b128 v[172:175], v227 offset:3584
    s_waitcnt lgkmcnt(7)
    v_mfma_f32_16x16x32_bf16 v[144:147], v[52:55], v[184:187], v[144:147]
    ds_read_b128 v[176:179], v227 offset:1536
    buffer_load_dwordx4 v215, s[8:11], s17 offen offset:3072 lds
    v_mfma_f32_16x16x32_bf16 v[148:151], v[84:87], v[184:187], v[148:151]
    s_waitcnt lgkmcnt(7)
    v_mfma_f32_16x16x32_bf16 v[144:147], v[48:51], v[188:191], v[144:147]
    ds_read_b128 v[180:183], v226 offset:3584
    ds_read_b64 v[156:157], v234 offset:0
    ds_read_b64 v[158:159], v234 offset:29952
    ds_read_b64 v[164:165], v234 offset:1024
    ds_read_b64 v[166:167], v234 offset:30976
    s_add_u32 m0, s19, 4096
    s_nop 0
    buffer_load_dwordx4 v216, s[8:11], s17 offen offset:0 lds
    v_mfma_f32_16x16x32_bf16 v[148:151], v[80:83], v[188:191], v[148:151]
    s_waitcnt lgkmcnt(11)
    v_mfma_f32_16x16x32_bf16 v[144:147], v[44:47], v[192:195], v[144:147]
    ds_read_b128 v[184:187], v226 offset:1536
    buffer_load_dwordx4 v217, s[8:11], s17 offen offset:1024 lds
    v_mfma_f32_16x16x32_bf16 v[148:151], v[76:79], v[192:195], v[148:151]
    s_waitcnt lgkmcnt(11)
    v_mfma_f32_16x16x32_bf16 v[144:147], v[40:43], v[196:199], v[144:147]
    ds_read_b128 v[188:191], v225 offset:3584
    buffer_load_dwordx4 v218, s[8:11], s17 offen offset:2048 lds
    s_add_u32 s17, s17, 229376
    v_mfma_f32_16x16x32_bf16 v[148:151], v[72:75], v[196:199], v[148:151]
    s_waitcnt lgkmcnt(11)
    v_mfma_f32_16x16x32_bf16 v[144:147], v[36:39], v[200:203], v[144:147]
    ds_read_b128 v[192:195], v225 offset:1536
    s_waitcnt lgkmcnt(3)
    v_lshlrev_b32 v152, 16, v156
    v_and_b32 v153, s36, v156
    s_add_u32 m0, s19, 28704
    s_nop 0
    buffer_load_dwordx4 v212, s[8:11], s17 offen offset:0 lds
    v_mfma_f32_16x16x32_bf16 v[148:151], v[68:71], v[200:203], v[148:151]
    v_lshlrev_b32 v154, 16, v157
    v_and_b32 v155, s36, v157
    v_mfma_f32_16x16x32_bf16 v[144:147], v[32:35], v[204:207], v[144:147]
    ds_read_b128 v[196:199], v224 offset:3584
    v_mul_f32 v152, s42, v152
    v_mul_f32 v153, s42, v153
    buffer_load_dwordx4 v213, s[8:11], s17 offen offset:1024 lds
    v_mfma_f32_16x16x32_bf16 v[148:151], v[64:67], v[204:207], v[148:151]
    v_mul_f32 v154, s42, v154
    v_mul_f32 v155, s42, v155
    v_mfma_f32_16x16x32_bf16 v[144:147], v[96:99], v[208:211], v[144:147]
    ds_read_b128 v[200:203], v224 offset:1536
    v_cvt_pk_bf16_f32 v153, v152, v153
    v_cvt_pk_bf16_f32 v155, v154, v155
    buffer_load_dwordx4 v214, s[8:11], s17 offen offset:2048 lds
    v_mfma_f32_16x16x32_bf16 v[148:151], v[60:63], v[172:175], v[148:151]
    ds_read_b128 v[204:207], v227 offset:4096
    v_lshlrev_b32 v152, 16, v153
    v_and_b32 v153, s36, v153
    v_mfma_f32_16x16x32_bf16 v[144:147], v[92:95], v[176:179], v[144:147]
    ds_read_b128 v[208:211], v227 offset:2048
    v_lshlrev_b32 v154, 16, v155
    v_and_b32 v155, s36, v155
    buffer_load_dwordx4 v215, s[8:11], s17 offen offset:3072 lds
    v_mfma_f32_16x16x32_bf16 v[148:151], v[56:59], v[180:183], v[148:151]
    ds_read_b128 v[172:175], v226 offset:4096
    v_lshlrev_b32 v156, 16, v158
    v_and_b32 v157, s36, v158
    s_waitcnt lgkmcnt(7)
    v_mfma_f32_16x16x32_bf16 v[144:147], v[88:91], v[184:187], v[144:147]
    ds_read_b128 v[176:179], v226 offset:2048
    v_lshlrev_b32 v158, 16, v159
    v_and_b32 v159, s36, v159
    s_add_u32 m0, s19, 32800
    s_nop 0
    buffer_load_dwordx4 v216, s[8:11], s17 offen offset:0 lds
    s_waitcnt lgkmcnt(7)
    v_mfma_f32_16x16x32_bf16 v[148:151], v[52:55], v[188:191], v[148:151]
    ds_read_b128 v[180:183], v225 offset:4096
    v_lshlrev_b32 v160, 16, v164
    v_and_b32 v161, s36, v164
    s_waitcnt lgkmcnt(7)
    v_mfma_f32_16x16x32_bf16 v[144:147], v[84:87], v[192:195], v[144:147]
    ds_read_b128 v[184:187], v225 offset:2048
    v_lshlrev_b32 v162, 16, v165
    v_and_b32 v163, s36, v165
    buffer_load_dwordx4 v217, s[8:11], s17 offen offset:1024 lds
    s_waitcnt lgkmcnt(7)
    v_mfma_f32_16x16x32_bf16 v[148:151], v[48:51], v[196:199], v[148:151]
    ds_read_b128 v[188:191], v224 offset:4096
    v_mul_f32 v160, s42, v160
    v_mul_f32 v161, s42, v161
    s_waitcnt lgkmcnt(7)
    v_mfma_f32_16x16x32_bf16 v[144:147], v[80:83], v[200:203], v[144:147]
L_ka_w8:
    ds_read_b32 v255, v253 offset:12
    s_waitcnt lgkmcnt(0)
    v_readfirstlane_b32 s63, v255
    s_nop 0
    s_cmp_lt_u32 s63, 1
    s_cbranch_scc1 L_ka_w8
    ds_read_b64_tr_b16 v[192:193], v231 offset:0
    ds_read_b64_tr_b16 v[194:195], v231 offset:32
    v_mul_f32 v162, s42, v162
    v_mul_f32 v163, s42, v163
    buffer_load_dwordx4 v218, s[8:11], s17 offen offset:2048 lds
    s_add_u32 s17, s17, 229376
    v_mfma_f32_16x16x32_bf16 v[148:151], v[44:47], v[204:207], v[148:151]
    ds_read_b64_tr_b16 v[196:197], v231 offset:256
    ds_read_b64_tr_b16 v[198:199], v231 offset:288
    v_cvt_pk_bf16_f32 v161, v160, v161
    v_cvt_pk_bf16_f32 v163, v162, v163
    v_mfma_f32_16x16x32_bf16 v[144:147], v[76:79], v[208:211], v[144:147]
    ds_read_b64_tr_b16 v[200:201], v231 offset:512
    ds_read_b64_tr_b16 v[202:203], v231 offset:544
    v_lshlrev_b32 v160, 16, v161
    v_and_b32 v161, s36, v161
    v_mfma_f32_16x16x32_bf16 v[148:151], v[40:43], v[172:175], v[148:151]
    ds_read_b64_tr_b16 v[204:205], v231 offset:768
    ds_read_b64_tr_b16 v[206:207], v231 offset:800
    v_lshlrev_b32 v162, 16, v163
    v_and_b32 v163, s36, v163
    v_mfma_f32_16x16x32_bf16 v[144:147], v[72:75], v[176:179], v[144:147]
    v_lshlrev_b32 v164, 16, v166
    v_and_b32 v165, s36, v166
    v_mfma_f32_16x16x32_bf16 v[148:151], v[36:39], v[180:183], v[148:151]
    v_lshlrev_b32 v166, 16, v167
    v_and_b32 v167, s36, v167
    v_mfma_f32_16x16x32_bf16 v[144:147], v[68:71], v[184:187], v[144:147]
    v_mfma_f32_16x16x32_bf16 v[148:151], v[32:35], v[188:191], v[148:151]
    s_waitcnt lgkmcnt(6)
    v_mfma_f32_16x16x32_bf16 v[144:147], v[192:195], v[108:111], v[144:147]
    v_mfma_f32_16x16x32_bf16 v[148:151], v[192:195], v[116:119], v[148:151]
    s_waitcnt lgkmcnt(4)
    v_mfma_f32_16x16x32_bf16 v[144:147], v[196:199], v[104:107], v[144:147]
    v_mfma_f32_16x16x32_bf16 v[148:151], v[196:199], v[112:115], v[148:151]
    s_waitcnt lgkmcnt(2)
    v_mfma_f32_16x16x32_bf16 v[148:151], v[200:203], v[108:111], v[148:151]
    s_waitcnt lgkmcnt(0)
    v_mfma_f32_16x16x32_bf16 v[148:151], v[204:207], v[104:107], v[148:151]
    s_branch L_ka_epi
.p2align 6
L_ka_warm2:
    s_branch L_ka_back2
L_ka_r2:
    s_setprio 0
    s_waitcnt lgkmcnt(0)
    s_barrier
    ds_read_b128 v[172:175], v224 offset:4096
    ds_read_b128 v[176:179], v227 offset:4608
    ds_read_b128 v[180:183], v226 offset:4608
    s_waitcnt lgkmcnt(2)
    v_mfma_f32_16x16x32_bf16 v[144:147], v[64:67], v[172:175], 0
    ds_read_b128 v[184:187], v225 offset:4608
    ds_read_b128 v[188:191], v224 offset:4608
    v_mfma_f32_16x16x32_bf16 v[148:151], v[96:99], v[172:175], 0
    ds_read_b128 v[192:195], v227 offset:5120
    s_waitcnt lgkmcnt(4)
    v_mfma_f32_16x16x32_bf16 v[144:147], v[60:63], v[176:179], v[144:147]
    ds_read_b128 v[196:199], v226 offset:5120
    v_mfma_f32_16x16x32_bf16 v[148:151], v[92:95], v[176:179], v[148:151]
    ds_read_b128 v[200:203], v225 offset:5120
    s_waitcnt lgkmcnt(5)
    v_mfma_f32_16x16x32_bf16 v[144:147], v[56:59], v[180:183], v[144:147]
    ds_read_b128 v[204:207], v224 offset:5120
    ds_read_b128 v[208:211], v224 offset:3072
    v_mfma_f32_16x16x32_bf16 v[148:151], v[88:91], v[180:183], v[148:151]
    ds_read_b128 v[172:175], v227 offset:5632
    s_waitcnt lgkmcnt(7)
    v_mfma_f32_16x16x32_bf16 v[144:147], v[52:55], v[184:187], v[144:147]
    ds_read_b128 v[176:179], v227 offset:3584
    v_mfma_f32_16x16x32_bf16 v[148:151], v[84:87], v[184:187], v[148:151]
    s_waitcnt lgkmcnt(7)
    v_mfma_f32_16x16x32_bf16 v[144:147], v[48:51], v[188:191], v[144:147]
    ds_read_b128 v[180:183], v226 offset:5632
    ds_read_b64 v[156:157], v234 offset:0
    ds_read_b64 v[158:159], v234 offset:29952
    ds_read_b64 v[164:165], v234 offset:1024
    ds_read_b64 v[166:167], v234 offset:30976
    v_mfma_f32_16x16x32_bf16 v[148:151], v[80:83], v[188:191], v[148:151]
    s_waitcnt lgkmcnt(11)
    v_mfma_f32_16x16x32_bf16 v[144:147], v[44:47], v[192:195], v[144:147]
    ds_read_b128 v[184:187], v226 offset:3584
    v_mfma_f32_16x16x32_bf16 v[148:151], v[76:79], v[192:195], v[148:151]
    s_waitcnt lgkmcnt(11)
    v_mfma_f32_16x16x32_bf16 v[144:147], v[40:43], v[196:199], v[144:147]
    ds_read_b128 v[188:191], v225 offset:5632
    v_mfma_f32_16x16x32_bf16 v[148:151], v[72:75], v[196:199], v[148:151]
    s_waitcnt lgkmcnt(11)
    v_mfma_f32_16x16x32_bf16 v[144:147], v[36:39], v[200:203], v[144:147]
    ds_read_b128 v[192:195], v225 offset:3584
    s_waitcnt lgkmcnt(3)
    v_lshlrev_b32 v152, 16, v156
    v_and_b32 v153, s36, v156
    v_mfma_f32_16x16x32_bf16 v[148:151], v[68:71], v[200:203], v[148:151]
    v_lshlrev_b32 v154, 16, v157
    v_and_b32 v155, s36, v157
    v_mfma_f32_16x16x32_bf16 v[144:147], v[32:35], v[204:207], v[144:147]
    ds_read_b128 v[196:199], v224 offset:5632
    v_mul_f32 v152, s42, v152
    v_mul_f32 v153, s42, v153
    v_mfma_f32_16x16x32_bf16 v[148:151], v[64:67], v[204:207], v[148:151]
    v_mul_f32 v154, s42, v154
    v_mul_f32 v155, s42, v155
    v_mfma_f32_16x16x32_bf16 v[144:147], v[96:99], v[208:211], v[144:147]
    ds_read_b128 v[200:203], v224 offset:3584
    v_cvt_pk_bf16_f32 v153, v152, v153
    v_cvt_pk_bf16_f32 v155, v154, v155
    v_mfma_f32_16x16x32_bf16 v[148:151], v[60:63], v[172:175], v[148:151]
    ds_read_b128 v[204:207], v227 offset:6144
    v_lshlrev_b32 v152, 16, v153
    v_and_b32 v153, s36, v153
    v_mfma_f32_16x16x32_bf16 v[144:147], v[92:95], v[176:179], v[144:147]
    ds_read_b128 v[208:211], v227 offset:4096
    v_lshlrev_b32 v154, 16, v155
    v_and_b32 v155, s36, v155
    v_mfma_f32_16x16x32_bf16 v[148:151], v[56:59], v[180:183], v[148:151]
    ds_read_b128 v[172:175], v226 offset:6144
    v_lshlrev_b32 v156, 16, v158
    v_and_b32 v157, s36, v158
    s_waitcnt lgkmcnt(7)
    v_mfma_f32_16x16x32_bf16 v[144:147], v[88:91], v[184:187], v[144:147]
    ds_read_b128 v[176:179], v226 offset:4096
    v_lshlrev_b32 v158, 16, v159
    v_and_b32 v159, s36, v159
    s_waitcnt lgkmcnt(7)
    v_mfma_f32_16x16x32_bf16 v[148:151], v[52:55], v[188:191], v[148:151]
    ds_read_b128 v[180:183], v225 offset:6144
    v_lshlrev_b32 v160, 16, v164
    v_and_b32 v161, s36, v164
    s_waitcnt lgkmcnt(7)
    v_mfma_f32_16x16x32_bf16 v[144:147], v[84:87], v[192:195], v[144:147]
    ds_read_b128 v[184:187], v225 offset:4096
    v_lshlrev_b32 v162, 16, v165
    v_and_b32 v163, s36, v165
    s_waitcnt lgkmcnt(7)
    v_mfma_f32_16x16x32_bf16 v[148:151], v[48:51], v[196:199], v[148:151]
    ds_read_b128 v[188:191], v224 offset:6144
    v_mul_f32 v160, s42, v160
    v_mul_f32 v161, s42, v161
    s_waitcnt lgkmcnt(7)
    v_mfma_f32_16x16x32_bf16 v[144:147], v[80:83], v[200:203], v[144:147]
    ds_read_b128 v[192:195], v224 offset:1024
    v_mul_f32 v162, s42, v162
    v_mul_f32 v163, s42, v163
    s_waitcnt lgkmcnt(7)
    v_mfma_f32_16x16x32_bf16 v[148:151], v[44:47], v[204:207], v[148:151]
    ds_read_b128 v[196:199], v224 offset:2048
    v_cvt_pk_bf16_f32 v161, v160, v161
    v_cvt_pk_bf16_f32 v163, v162, v163
    s_waitcnt lgkmcnt(7)
    v_mfma_f32_16x16x32_bf16 v[144:147], v[76:79], v[208:211], v[144:147]
L_ka_w9:
    ds_read_b32 v255, v253 offset:12
    s_waitcnt lgkmcnt(0)
    v_readfirstlane_b32 s63, v255
    s_nop 0
    s_cmp_lt_u32 s63, 1
    s_cbranch_scc1 L_ka_w9
    ds_read_b64_tr_b16 v[200:201], v232 offset:6400
    ds_read_b64_tr_b16 v[202:203], v232 offset:6464
    v_lshlrev_b32 v160, 16, v161
    v_and_b32 v161, s36, v161
    v_mfma_f32_16x16x32_bf16 v[148:151], v[40:43], v[172:175], v[148:151]
    ds_read_b64_tr_b16 v[204:205], v232 offset:6912
    ds_read_b64_tr_b16 v[206:207], v232 offset:6976
    v_lshlrev_b32 v162, 16, v163
    v_and_b32 v163, s36, v163
    v_mfma_f32_16x16x32_bf16 v[144:147], v[72:75], v[176:179], v[144:147]
    ds_read_b64_tr_b16 v[208:209], v231 offset:0
    ds_read_b64_tr_b16 v[210:211], v231 offset:32
    v_lshlrev_b32 v164, 16, v166
    v_and_b32 v165, s36, v166
    v_mfma_f32_16x16x32_bf16 v[148:151], v[36:39], v[180:183], v[148:151]
    ds_read_b64_tr_b16 v[172:173], v231 offset:256
    ds_read_b64_tr_b16 v[174:175], v231 offset:288
    v_lshlrev_b32 v166, 16, v167
    v_and_b32 v167, s36, v167
    v_mfma_f32_16x16x32_bf16 v[144:147], v[68:71], v[184:187], v[144:147]
    ds_read_b64_tr_b16 v[176:177], v231 offset:512
    ds_read_b64_tr_b16 v[178:179], v231 offset:544
    v_mfma_f32_16x16x32_bf16 v[148:151], v[32:35], v[188:191], v[148:151]
    ds_read_b64_tr_b16 v[180:181], v231 offset:768
    ds_read_b64_tr_b16 v[182:183], v231 offset:800
    v_mfma_f32_16x16x32_bf16 v[144:147], v[100:103], v[192:195], v[144:147]
    ds_read_b64_tr_b16 v[184:185], v231 offset:1024
    ds_read_b64_tr_b16 v[186:187], v231 offset:1056
    v_mfma_f32_16x16x32_bf16 v[148:151], v[100:103], v[196:199], v[148:151]
    ds_read_b64_tr_b16 v[188:189], v231 offset:1280
    ds_read_b64_tr_b16 v[190:191], v231 offset:1312
    s_waitcnt lgkmcnt(14)
    v_mfma_f32_16x16x32_bf16 v[144:147], v[200:203], v[128:131], v[144:147]
    ds_read_b64_tr_b16 v[192:193], v231 offset:1536
    ds_read_b64_tr_b16 v[194:195], v231 offset:1568
    v_mfma_f32_16x16x32_bf16 v[148:151], v[200:203], v[132:135], v[148:151]
    s_waitcnt lgkmcnt(14)
    v_mfma_f32_16x16x32_bf16 v[148:151], v[204:207], v[128:131], v[148:151]
    ds_read_b64_tr_b16 v[196:197], v231 offset:1792
    ds_read_b64_tr_b16 v[198:199], v231 offset:1824
    s_waitcnt lgkmcnt(14)
    v_mfma_f32_16x16x32_bf16 v[144:147], v[208:211], v[124:127], v[144:147]
    s_waitcnt lgkmcnt(12)
    v_mfma_f32_16x16x32_bf16 v[144:147], v[172:175], v[120:123], v[144:147]
    s_waitcnt lgkmcnt(10)
    v_mfma_f32_16x16x32_bf16 v[144:147], v[176:179], v[116:119], v[144:147]
    v_mfma_f32_16x16x32_bf16 v[148:151], v[176:179], v[124:127], v[148:151]
    s_waitcnt lgkmcnt(8)
    v_mfma_f32_16x16x32_bf16 v[144:147], v[180:183], v[112:115], v[144:147]
    v_mfma_f32_16x16x32_bf16 v[148:151], v[180:183], v[120:123], v[148:151]
    s_waitcnt lgkmcnt(6)
    v_mfma_f32_16x16x32_bf16 v[144:147], v[184:187], v[108:111], v[144:147]
    v_mfma_f32_16x16x32_bf16 v[148:151], v[184:187], v[116:119], v[148:151]
    s_waitcnt lgkmcnt(4)
    v_mfma_f32_16x16x32_bf16 v[144:147], v[188:191], v[104:107], v[144:147]
    v_mfma_f32_16x16x32_bf16 v[148:151], v[188:191], v[112:115], v[148:151]
    s_waitcnt lgkmcnt(2)
    v_mfma_f32_16x16x32_bf16 v[148:151], v[192:195], v[108:111], v[148:151]
    s_waitcnt lgkmcnt(0)
    v_mfma_f32_16x16x32_bf16 v[148:151], v[196:199], v[104:107], v[148:151]
    s_branch L_ka_epi
.p2align 6
L_ka_warm3:
    s_branch L_ka_back3
L_ka_epi:
    s_nop 7
    v_cvt_pk_bf16_f32 v145, v144, v145
    v_cvt_pk_bf16_f32 v147, v146, v147
    v_cvt_pk_bf16_f32 v149, v148, v149
    v_cvt_pk_bf16_f32 v151, v150, v151
    v_lshlrev_b32 v144, 16, v145
    v_and_b32 v145, s36, v145
    v_lshlrev_b32 v146, 16, v147
    v_and_b32 v147, s36, v147
    v_lshlrev_b32 v148, 16, v149
    v_and_b32 v149, s36, v149
    v_lshlrev_b32 v150, 16, v151
    v_and_b32 v151, s36, v151
    v_add_f32 v144, v144, v152
    v_add_f32 v145, v145, v153
    v_add_f32 v146, v146, v154
    v_add_f32 v147, v147, v155
    v_add_f32 v148, v148, v160
    v_add_f32 v149, v149, v161
    v_add_f32 v150, v150, v162
    v_add_f32 v151, v151, v163
    v_cvt_pk_bf16_f32 v145, v144, v145
    v_cvt_pk_bf16_f32 v147, v146, v147
    v_cvt_pk_bf16_f32 v149, v148, v149
    v_cvt_pk_bf16_f32 v151, v150, v151
    v_lshlrev_b32 v144, 16, v145
    v_and_b32 v145, s36, v145
    v_lshlrev_b32 v146, 16, v147
    v_and_b32 v147, s36, v147
    v_lshlrev_b32 v148, 16, v149
    v_and_b32 v149, s36, v149
    v_lshlrev_b32 v150, 16, v151
    v_and_b32 v151, s36, v151
    v_add_f32 v144, v144, v156
    v_add_f32 v145, v145, v157
    v_add_f32 v146, v146, v158
    v_add_f32 v147, v147, v159
    v_add_f32 v148, v148, v164
    v_add_f32 v149, v149, v165
    v_add_f32 v150, v150, v166
    v_add_f32 v151, v151, v167
    v_cvt_pk_bf16_f32 v168, v144, v145
    v_cvt_pk_bf16_f32 v169, v146, v147
    v_cvt_pk_bf16_f32 v170, v148, v149
    v_cvt_pk_bf16_f32 v171, v150, v151
    s_nop 0
    v_permlane16_swap_b32 v168, v170
    v_permlane16_swap_b32 v169, v171
    global_store_dwordx4 v235, v[168:171], s[58:59] sc1
    s_setprio 0
    s_load_dwordx2 s[6:7], s[0:1], 88
    s_and_b32 s28, s2, 15
    s_mul_i32 s28, s28, 256
    s_add_u32 s28, s28, 25296896
    v_mul_u32_u24 v250, 4096, v1
    v_add_u32 v250, s28, v250
    s_and_b32 s12, s26, 3
    s_and_b32 s24, s2, 7
    s_lshr_b32 s25, s2, 3
    s_lshr_b32 s13, s24, 2
    s_lshl_b32 s13, s13, 3
    s_and_b32 s28, s25, 7
    s_add_u32 s13, s13, s28
    s_and_b32 s14, s24, 3
    s_lshl_b32 s14, s14, 2
    s_lshr_b32 s28, s25, 3
    s_add_u32 s14, s14, s28
    s_lshl_b32 s15, s24, 2
    s_and_b32 s28, s25, 3
    s_add_u32 s15, s15, s28
    s_lshr_b32 s16, s25, 2
    s_and_b32 s39, s12, 1
    s_lshr_b32 s40, s12, 1
    v_lshlrev_b32 v229, 4, v1
    s_mov_b32 s8, s58
    s_mov_b32 s9, s59
    s_mov_b32 s10, 27262976
    s_mov_b32 s11, 0x20000
    s_mul_i32 s43, s16, 229376
    s_add_u32 s43, s43, 12582912
    s_lshl_b32 s18, s13, 2
    s_add_u32 s18, s18, s12
    s_mul_i32 s18, s18, 33024
    s_add_u32 s18, s18, 4718592
    s_lshl_b32 s4, s12, 12
    s_add_u32 s4, s4, 86528
    s_waitcnt vmcnt(0)
    s_mov_b64 exec, 1
    ds_add_rtn_u32 v255, v252, v254 offset:48
    s_waitcnt lgkmcnt(0)
    v_readfirstlane_b32 s63, v255
    s_nop 0
    s_cmp_lg_u32 s63, 7
    s_cbranch_scc1 L_kf_na2
    s_mov_b32 exec_lo, 0xff
    s_mov_b32 exec_hi, 0
    global_atomic_add v250, v254, s[58:59] sc1
    s_mov_b64 exec, 1
    ds_add_u32 v252, v254 offset:52
L_kf_na2:
    s_mov_b64 exec, -1
    s_cmp_ge_u32 s26, 4
    s_cbranch_scc1 L_kf_loader
    v_lshrrev_b32 v2, 4, v1
    v_lshrrev_b32 v3, 2, v1
    v_mul_u32_u24 v4, 224, v3
    v_and_b32 v5, 1, v1
    v_mul_u32_u24 v5, 14352, v5
    v_bfe_u32 v6, v1, 1, 1
    v_lshl_add_u32 v5, v6, 3, v5
    s_mul_i32 s24, s39, 112
    v_add3_u32 v4, v4, v5, s24
    v_add_u32 v220, 0, v4
    v_add_u32 v221, 28704, v4
    v_add_u32 v222, 57408, v4
    v_lshlrev_b32 v3, 6, v3
    v_and_b32 v4, 3, v1
    v_lshl_add_u32 v3, v4, 3, v3
    v_and_b32 v5, 1, v2
    v_lshl_add_u32 v3, v5, 5, v3
    s_lshl_b32 s24, s40, 13
    s_add_u32 s24, s24, 86528
    v_add_u32 v223, s24, v3
    v_xor_b32 v224, 32, v223
    v_mul_u32_u24 v3, 1792, v2
    v_bfe_u32 v5, v1, 2, 1
    v_mul_u32_u24 v5, 448, v5
    v_bfe_u32 v6, v1, 3, 1
    v_lshl_add_u32 v6, v6, 2, v4
    v_lshl_add_u32 v5, v6, 2, v5
    s_mul_i32 s24, s39, 224
    s_add_u32 s24, s24, 135680
    v_add3_u32 v230, v3, v5, s24
    s_lshl_b32 s24, s40, 9
    s_add_u32 s24, s24, 152064
    v_and_b32 v3, 15, v1
    v_lshl_add_u32 v231, v3, 3, s24
    v_and_b32 v4, 31, v1
    v_lshl_add_u32 v219, v4, 3, s24
    s_lshl_b32 s24, s13, 3
    s_lshl_b32 s25, s40, 2
    s_add_u32 s24, s24, s25
    s_mul_i32 s24, s24, 57472
    s_add_u32 s24, s24, 16777216
    s_lshl_b32 s25, s14, 1
    s_add_u32 s25, s25, s39
    s_lshl_b32 s28, s25, 10
    s_add_u32 s41, s24, s28
    s_mul_i32 s28, s25, 768
    s_add_u32 s42, s24, s28
    s_add_u32 s42, s42, 32768
    v_mul_u32_u24 v2, 57472, v2
    v_lshl_add_u32 v218, v3, 4, v2
    s_lshl_b32 s44, s12, 13
    s_add_u32 s44, s44, 5120
    s_mul_i32 s29, s12, 6144
    s_add_u32 s29, s29, 35840
    s_lshl_b32 s24, s13, 3
    s_lshl_b32 s25, s40, 2
    s_add_u32 s24, s24, s25
    s_lshr_b32 s25, s14, 2
    s_add_u32 s24, s24, s25
    s_mul_i32 s24, s24, 256
    s_add_u32 s24, s24, 25362432
    v_mov_b32 v216, s24
    v_add_u32 v217, 65536, v216
L_ka_w10:
    ds_read_b32 v255, v252 offset:56
    s_waitcnt lgkmcnt(0)
    v_readfirstlane_b32 s63, v255
    s_nop 0
    s_cmp_lt_u32 s63, 1
    s_cbranch_scc1 L_ka_w10
    s_add_u32 m0, s4, 0
    s_nop 0
    buffer_load_dwordx4 v229, s[8:11], s18 offen offset:0 sc1 lds
    buffer_load_dwordx4 v229, s[8:11], s18 offen offset:1024 sc1 lds
    buffer_load_dwordx4 v229, s[8:11], s18 offen offset:2048 sc1 lds
    buffer_load_dwordx4 v229, s[8:11], s18 offen offset:3072 sc1 lds
    s_add_u32 s18, s18, 4096
    s_add_u32 m0, s4, 16384
    s_nop 0
    buffer_load_dwordx4 v229, s[8:11], s18 offen offset:0 sc1 lds
    buffer_load_dwordx4 v229, s[8:11], s18 offen offset:1024 sc1 lds
    buffer_load_dwordx4 v229, s[8:11], s18 offen offset:2048 sc1 lds
    buffer_load_dwordx4 v229, s[8:11], s18 offen offset:3072 sc1 lds
    s_add_u32 s18, s18, 4096
    s_setprio 1
    s_waitcnt vmcnt(4)
    s_barrier
    ds_read_b64_tr_b16 v[156:157], v223 offset:0
    ds_read_b64_tr_b16 v[158:159], v223 offset:1024
    ds_read_b64_tr_b16 v[128:129], v220 offset:0
    ds_read_b64_tr_b16 v[130:131], v220 offset:3584
    ds_read_b64_tr_b16 v[160:161], v224 offset:0
    ds_read_b64_tr_b16 v[162:163], v224 offset:1024
    ds_read_b64_tr_b16 v[164:165], v223 offset:4096
    ds_read_b64_tr_b16 v[166:167], v223 offset:5120
    ds_read_b64_tr_b16 v[168:169], v224 offset:4096
    ds_read_b64_tr_b16 v[170:171], v224 offset:5120
    ds_read_b64_tr_b16 v[132:133], v220 offset:16
    ds_read_b64_tr_b16 v[134:135], v220 offset:3600
    s_waitcnt lgkmcnt(8)
    v_mfma_f32_16x16x32_bf16 v[16:19], v[128:131], v[156:159], 0
    ds_read_b64_tr_b16 v[136:137], v220 offset:32
    ds_read_b64_tr_b16 v[138:139], v220 offset:3616
    s_waitcnt lgkmcnt(8)
    v_mfma_f32_16x16x32_bf16 v[20:23], v[128:131], v[160:163], 0
    ds_read_b64_tr_b16 v[140:141], v220 offset:48
    s_waitcnt lgkmcnt(7)
    v_mfma_f32_16x16x32_bf16 v[24:27], v[128:131], v[164:167], 0
    ds_read_b64_tr_b16 v[142:143], v220 offset:3632
    s_waitcnt lgkmcnt(6)
    v_mfma_f32_16x16x32_bf16 v[28:31], v[128:131], v[168:171], 0
    ds_read_b64_tr_b16 v[172:173], v223 offset:2048
    s_waitcnt lgkmcnt(5)
    v_mfma_f32_16x16x32_bf16 v[32:35], v[132:135], v[156:159], 0
    ds_read_b64_tr_b16 v[174:175], v223 offset:3072
    ds_read_b64_tr_b16 v[144:145], v220 offset:64
    v_mfma_f32_16x16x32_bf16 v[36:39], v[132:135], v[160:163], 0
    ds_read_b64_tr_b16 v[146:147], v220 offset:3648
    v_mfma_f32_16x16x32_bf16 v[40:43], v[132:135], v[164:167], 0
    ds_read_b64_tr_b16 v[176:177], v224 offset:2048
    v_mfma_f32_16x16x32_bf16 v[44:47], v[132:135], v[168:171], 0
    ds_read_b64_tr_b16 v[178:179], v224 offset:3072
    s_waitcnt lgkmcnt(8)
    v_mfma_f32_16x16x32_bf16 v[48:51], v[136:139], v[156:159], 0
    ds_read_b64_tr_b16 v[148:149], v220 offset:80
    ds_read_b64_tr_b16 v[150:151], v220 offset:3664
    v_mfma_f32_16x16x32_bf16 v[52:55], v[136:139], v[160:163], 0
    ds_read_b64_tr_b16 v[180:181], v223 offset:6144
    v_mfma_f32_16x16x32_bf16 v[56:59], v[136:139], v[164:167], 0
    ds_read_b64_tr_b16 v[182:183], v223 offset:7168
    v_mfma_f32_16x16x32_bf16 v[60:63], v[136:139], v[168:171], 0
    ds_read_b64_tr_b16 v[152:153], v220 offset:96
    s_waitcnt lgkmcnt(11)
    v_mfma_f32_16x16x32_bf16 v[64:67], v[140:143], v[156:159], 0
    ds_read_b64_tr_b16 v[154:155], v220 offset:3680
    ds_read_b64_tr_b16 v[184:185], v224 offset:6144
    v_mfma_f32_16x16x32_bf16 v[68:71], v[140:143], v[160:163], 0
    ds_read_b64_tr_b16 v[186:187], v224 offset:7168
    v_mfma_f32_16x16x32_bf16 v[72:75], v[140:143], v[164:167], 0
    ds_read_b64_tr_b16 v[128:129], v220 offset:7168
    v_mfma_f32_16x16x32_bf16 v[76:79], v[140:143], v[168:171], 0
    ds_read_b64_tr_b16 v[130:131], v220 offset:10752
    s_waitcnt lgkmcnt(12)
    v_mfma_f32_16x16x32_bf16 v[80:83], v[144:147], v[156:159], 0
    ds_read_b64_tr_b16 v[132:133], v220 offset:7184
    ds_read_b64_tr_b16 v[134:135], v220 offset:10768
    v_mfma_f32_16x16x32_bf16 v[84:87], v[144:147], v[160:163], 0
    ds_read_b64_tr_b16 v[136:137], v220 offset:7200
    v_mfma_f32_16x16x32_bf16 v[88:91], v[144:147], v[164:167], 0
    ds_read_b64_tr_b16 v[138:139], v220 offset:10784
    v_mfma_f32_16x16x32_bf16 v[92:95], v[144:147], v[168:171], 0
    s_waitcnt lgkmcnt(12)
    v_mfma_f32_16x16x32_bf16 v[96:99], v[148:151], v[156:159], 0
    ds_read_b64_tr_b16 v[140:141], v220 offset:7216
    ds_read_b64_tr_b16 v[142:143], v220 offset:10800
    v_mfma_f32_16x16x32_bf16 v[100:103], v[148:151], v[160:163], 0
    v_mfma_f32_16x16x32_bf16 v[104:107], v[148:151], v[164:167], 0
    v_mfma_f32_16x16x32_bf16 v[108:111], v[148:151], v[168:171], 0
    s_waitcnt lgkmcnt(10)
    v_mfma_f32_16x16x32_bf16 v[112:115], v[152:155], v[156:159], 0
    ds_read_b64_tr_b16 v[144:145], v220 offset:7232
    ds_read_b64_tr_b16 v[146:147], v220 offset:10816
    v_mfma_f32_16x16x32_bf16 v[116:119], v[152:155], v[160:163], 0
    v_mfma_f32_16x16x32_bf16 v[120:123], v[152:155], v[164:167], 0
    v_mfma_f32_16x16x32_bf16 v[124:127], v[152:155], v[168:171], 0
    s_waitcnt lgkmcnt(8)
    v_mfma_f32_16x16x32_bf16 v[16:19], v[128:131], v[172:175], v[16:19]
    ds_read_b64_tr_b16 v[148:149], v220 offset:7248
    ds_read_b64_tr_b16 v[150:151], v220 offset:10832
    v_mfma_f32_16x16x32_bf16 v[20:23], v[128:131], v[176:179], v[20:23]
    v_mfma_f32_16x16x32_bf16 v[24:27], v[128:131], v[180:183], v[24:27]
    v_mfma_f32_16x16x32_bf16 v[28:31], v[128:131], v[184:187], v[28:31]
    s_waitcnt lgkmcnt(8)
    v_mfma_f32_16x16x32_bf16 v[32:35], v[132:135], v[172:175], v[32:35]
    ds_read_b64_tr_b16 v[152:153], v220 offset:7264
    ds_read_b64_tr_b16 v[154:155], v220 offset:10848
    v_mfma_f32_16x16x32_bf16 v[36:39], v[132:135], v[176:179], v[36:39]
    v_mfma_f32_16x16x32_bf16 v[40:43], v[132:135], v[180:183], v[40:43]
    v_mfma_f32_16x16x32_bf16 v[44:47], v[132:135], v[184:187], v[44:47]
    s_waitcnt lgkmcnt(8)
    v_mfma_f32_16x16x32_bf16 v[48:51], v[136:139], v[172:175], v[48:51]
    v_mfma_f32_16x16x32_bf16 v[52:55], v[136:139], v[176:179], v[52:55]
    v_mfma_f32_16x16x32_bf16 v[56:59], v[136:139], v[180:183], v[56:59]
    v_mfma_f32_16x16x32_bf16 v[60:63], v[136:139], v[184:187], v[60:63]
    s_waitcnt lgkmcnt(6)
    v_mfma_f32_16x16x32_bf16 v[64:67], v[140:143], v[172:175], v[64:67]
    v_mfma_f32_16x16x32_bf16 v[68:71], v[140:143], v[176:179], v[68:71]
    v_mfma_f32_16x16x32_bf16 v[72:75], v[140:143], v[180:183], v[72:75]
    v_mfma_f32_16x16x32_bf16 v[76:79], v[140:143], v[184:187], v[76:79]
    s_waitcnt lgkmcnt(0)
    s_waitcnt vmcnt(0)
    s_barrier
    v_mfma_f32_16x16x32_bf16 v[80:83], v[144:147], v[172:175], v[80:83]
    ds_read_b64_tr_b16 v[156:157], v223 offset:16384
    ds_read_b64_tr_b16 v[158:159], v223 offset:17408
    v_mfma_f32_16x16x32_bf16 v[84:87], v[144:147], v[176:179], v[84:87]
    ds_read_b64_tr_b16 v[128:129], v221 offset:0
    v_mfma_f32_16x16x32_bf16 v[88:91], v[144:147], v[180:183], v[88:91]
    ds_read_b64_tr_b16 v[130:131], v221 offset:3584
    v_mfma_f32_16x16x32_bf16 v[92:95], v[144:147], v[184:187], v[92:95]
    ds_read_b64_tr_b16 v[160:161], v224 offset:16384
    v_mfma_f32_16x16x32_bf16 v[96:99], v[148:151], v[172:175], v[96:99]
    ds_read_b64_tr_b16 v[162:163], v224 offset:17408
    ds_read_b64_tr_b16 v[164:165], v223 offset:20480
    v_mfma_f32_16x16x32_bf16 v[100:103], v[148:151], v[176:179], v[100:103]
    ds_read_b64_tr_b16 v[166:167], v223 offset:21504
    v_mfma_f32_16x16x32_bf16 v[104:107], v[148:151], v[180:183], v[104:107]
    ds_read_b64_tr_b16 v[168:169], v224 offset:20480
    v_mfma_f32_16x16x32_bf16 v[108:111], v[148:151], v[184:187], v[108:111]
    ds_read_b64_tr_b16 v[170:171], v224 offset:21504
    v_mfma_f32_16x16x32_bf16 v[112:115], v[152:155], v[172:175], v[112:115]
    ds_read_b64_tr_b16 v[132:133], v221 offset:16
    ds_read_b64_tr_b16 v[134:135], v221 offset:3600
    v_mfma_f32_16x16x32_bf16 v[116:119], v[152:155], v[176:179], v[116:119]
    ds_read_b64_tr_b16 v[136:137], v221 offset:32
    v_mfma_f32_16x16x32_bf16 v[120:123], v[152:155], v[180:183], v[120:123]
    ds_read_b64_tr_b16 v[138:139], v221 offset:3616
    v_mfma_f32_16x16x32_bf16 v[124:127], v[152:155], v[184:187], v[124:127]
    ds_read_b64_tr_b16 v[140:141], v221 offset:48
    s_waitcnt lgkmcnt(11)
    v_mfma_f32_16x16x32_bf16 v[16:19], v[128:131], v[156:159], v[16:19]
    ds_read_b64_tr_b16 v[142:143], v221 offset:3632
    ds_read_b64_tr_b16 v[172:173], v223 offset:18432
    s_waitcnt lgkmcnt(11)
    v_mfma_f32_16x16x32_bf16 v[20:23], v[128:131], v[160:163], v[20:23]
    ds_read_b64_tr_b16 v[174:175], v223 offset:19456
    s_waitcnt lgkmcnt(10)
    v_mfma_f32_16x16x32_bf16 v[24:27], v[128:131], v[164:167], v[24:27]
    ds_read_b64_tr_b16 v[144:145], v221 offset:64
    s_waitcnt lgkmcnt(9)
    v_mfma_f32_16x16x32_bf16 v[28:31], v[128:131], v[168:171], v[28:31]
    ds_read_b64_tr_b16 v[146:147], v221 offset:3648
    s_waitcnt lgkmcnt(8)
    v_mfma_f32_16x16x32_bf16 v[32:35], v[132:135], v[156:159], v[32:35]
    ds_read_b64_tr_b16 v[176:177], v224 offset:18432
    ds_read_b64_tr_b16 v[178:179], v224 offset:19456
    v_mfma_f32_16x16x32_bf16 v[36:39], v[132:135], v[160:163], v[36:39]
    ds_read_b64_tr_b16 v[148:149], v221 offset:80
    v_mfma_f32_16x16x32_bf16 v[40:43], v[132:135], v[164:167], v[40:43]
    ds_read_b64_tr_b16 v[150:151], v221 offset:3664
    v_mfma_f32_16x16x32_bf16 v[44:47], v[132:135], v[168:171], v[44:47]
    ds_read_b64_tr_b16 v[180:181], v223 offset:22528
    s_waitcnt lgkmcnt(11)
    v_mfma_f32_16x16x32_bf16 v[48:51], v[136:139], v[156:159], v[48:51]
    ds_read_b64_tr_b16 v[182:183], v223 offset:23552
    ds_read_b64_tr_b16 v[152:153], v221 offset:96
    v_mfma_f32_16x16x32_bf16 v[52:55], v[136:139], v[160:163], v[52:55]
    ds_read_b64_tr_b16 v[154:155], v221 offset:3680
    v_mfma_f32_16x16x32_bf16 v[56:59], v[136:139], v[164:167], v[56:59]
    ds_read_b64_tr_b16 v[184:185], v224 offset:22528
    v_mfma_f32_16x16x32_bf16 v[60:63], v[136:139], v[168:171], v[60:63]
    ds_read_b64_tr_b16 v[186:187], v224 offset:23552
    s_waitcnt lgkmcnt(14)
    v_mfma_f32_16x16x32_bf16 v[64:67], v[140:143], v[156:159], v[64:67]
    ds_read_b64_tr_b16 v[128:129], v221 offset:7168
    ds_read_b64_tr_b16 v[130:131], v221 offset:10752
    v_mfma_f32_16x16x32_bf16 v[68:71], v[140:143], v[160:163], v[68:71]
    ds_read_b64_tr_b16 v[132:133], v221 offset:7184
    v_mfma_f32_16x16x32_bf16 v[72:75], v[140:143], v[164:167], v[72:75]
    ds_read_b64_tr_b16 v[134:135], v221 offset:10768
    v_mfma_f32_16x16x32_bf16 v[76:79], v[140:143], v[168:171], v[76:79]
    s_waitcnt lgkmcnt(14)
    v_mfma_f32_16x16x32_bf16 v[80:83], v[144:147], v[156:159], v[80:83]
    ds_read_b64_tr_b16 v[136:137], v221 offset:7200
    ds_read_b64_tr_b16 v[138:139], v221 offset:10784
    v_mfma_f32_16x16x32_bf16 v[84:87], v[144:147], v[160:163], v[84:87]
    v_mfma_f32_16x16x32_bf16 v[88:91], v[144:147], v[164:167], v[88:91]
    v_mfma_f32_16x16x32_bf16 v[92:95], v[144:147], v[168:171], v[92:95]
    s_waitcnt lgkmcnt(12)
    v_mfma_f32_16x16x32_bf16 v[96:99], v[148:151], v[156:159], v[96:99]
    ds_read_b64_tr_b16 v[140:141], v221 offset:7216
    ds_read_b64_tr_b16 v[142:143], v221 offset:10800
    v_mfma_f32_16x16x32_bf16 v[100:103], v[148:151], v[160:163], v[100:103]
    v_mfma_f32_16x16x32_bf16 v[104:107], v[148:151], v[164:167], v[104:107]
    v_mfma_f32_16x16x32_bf16 v[108:111], v[148:151], v[168:171], v[108:111]
    s_waitcnt lgkmcnt(10)
    v_mfma_f32_16x16x32_bf16 v[112:115], v[152:155], v[156:159], v[112:115]
    ds_read_b64_tr_b16 v[144:145], v221 offset:7232
    ds_read_b64_tr_b16 v[146:147], v221 offset:10816
    v_mfma_f32_16x16x32_bf16 v[116:119], v[152:155], v[160:163], v[116:119]
    v_mfma_f32_16x16x32_bf16 v[120:123], v[152:155], v[164:167], v[120:123]
    v_mfma_f32_16x16x32_bf16 v[124:127], v[152:155], v[168:171], v[124:127]
    s_waitcnt lgkmcnt(8)
    v_mfma_f32_16x16x32_bf16 v[16:19], v[128:131], v[172:175], v[16:19]
    ds_read_b64_tr_b16 v[148:149], v221 offset:7248
    ds_read_b64_tr_b16 v[150:151], v221 offset:10832
    v_mfma_f32_16x16x32_bf16 v[20:23], v[128:131], v[176:179], v[20:23]
    v_mfma_f32_16x16x32_bf16 v[24:27], v[128:131], v[180:183], v[24:27]
    v_mfma_f32_16x16x32_bf16 v[28:31], v[128:131], v[184:187], v[28:31]
    s_waitcnt lgkmcnt(8)
    v_mfma_f32_16x16x32_bf16 v[32:35], v[132:135], v[172:175], v[32:35]
    ds_read_b64_tr_b16 v[152:153], v221 offset:7264
    ds_read_b64_tr_b16 v[154:155], v221 offset:10848
    v_mfma_f32_16x16x32_bf16 v[36:39], v[132:135], v[176:179], v[36:39]
    v_mfma_f32_16x16x32_bf16 v[40:43], v[132:135], v[180:183], v[40:43]
    v_mfma_f32_16x16x32_bf16 v[44:47], v[132:135], v[184:187], v[44:47]
    s_waitcnt lgkmcnt(8)
    v_mfma_f32_16x16x32_bf16 v[48:51], v[136:139], v[172:175], v[48:51]
    v_mfma_f32_16x16x32_bf16 v[52:55], v[136:139], v[176:179], v[52:55]
    v_mfma_f32_16x16x32_bf16 v[56:59], v[136:139], v[180:183], v[56:59]
    v_mfma_f32_16x16x32_bf16 v[60:63], v[136:139], v[184:187], v[60:63]
    s_waitcnt lgkmcnt(6)
    v_mfma_f32_16x16x32_bf16 v[64:67], v[140:143], v[172:175], v[64:67]
    v_mfma_f32_16x16x32_bf16 v[68:71], v[140:143], v[176:179], v[68:71]
    v_mfma_f32_16x16x32_bf16 v[72:75], v[140:143], v[180:183], v[72:75]
    v_mfma_f32_16x16x32_bf16 v[76:79], v[140:143], v[184:187], v[76:79]
    s_waitcnt lgkmcnt(0)
    s_barrier
    v_mfma_f32_16x16x32_bf16 v[80:83], v[144:147], v[172:175], v[80:83]
    ds_read_b64_tr_b16 v[156:157], v223 offset:32768
    ds_read_b64_tr_b16 v[158:159], v223 offset:33792
    v_mfma_f32_16x16x32_bf16 v[84:87], v[144:147], v[176:179], v[84:87]
    ds_read_b64_tr_b16 v[128:129], v222 offset:0
    v_mfma_f32_16x16x32_bf16 v[88:91], v[144:147], v[180:183], v[88:91]
    ds_read_b64_tr_b16 v[130:131], v222 offset:3584
    v_mfma_f32_16x16x32_bf16 v[92:95], v[144:147], v[184:187], v[92:95]
    ds_read_b64_tr_b16 v[160:161], v224 offset:32768
    v_mfma_f32_16x16x32_bf16 v[96:99], v[148:151], v[172:175], v[96:99]
    ds_read_b64_tr_b16 v[162:163], v224 offset:33792
    ds_read_b64_tr_b16 v[164:165], v223 offset:36864
    v_mfma_f32_16x16x32_bf16 v[100:103], v[148:151], v[176:179], v[100:103]
    ds_read_b64_tr_b16 v[166:167], v223 offset:37888
    v_mfma_f32_16x16x32_bf16 v[104:107], v[148:151], v[180:183], v[104:107]
    ds_read_b64_tr_b16 v[168:169], v224 offset:36864
    v_mfma_f32_16x16x32_bf16 v[108:111], v[148:151], v[184:187], v[108:111]
    ds_read_b64_tr_b16 v[170:171], v224 offset:37888
    v_mfma_f32_16x16x32_bf16 v[112:115], v[152:155], v[172:175], v[112:115]
    ds_read_b64_tr_b16 v[132:133], v222 offset:16
    ds_read_b64_tr_b16 v[134:135], v222 offset:3600
    v_mfma_f32_16x16x32_bf16 v[116:119], v[152:155], v[176:179], v[116:119]
    ds_read_b64_tr_b16 v[136:137], v222 offset:32
    v_mfma_f32_16x16x32_bf16 v[120:123], v[152:155], v[180:183], v[120:123]
    ds_read_b64_tr_b16 v[138:139], v222 offset:3616
    v_mfma_f32_16x16x32_bf16 v[124:127], v[152:155], v[184:187], v[124:127]
    ds_read_b64_tr_b16 v[140:141], v222 offset:48
    s_waitcnt lgkmcnt(11)
    v_mfma_f32_16x16x32_bf16 v[16:19], v[128:131], v[156:159], v[16:19]
    ds_read_b64_tr_b16 v[142:143], v222 offset:3632
    ds_read_b64_tr_b16 v[172:173], v223 offset:34816
    s_waitcnt lgkmcnt(11)
    v_mfma_f32_16x16x32_bf16 v[20:23], v[128:131], v[160:163], v[20:23]
    ds_read_b64_tr_b16 v[174:175], v223 offset:35840
    s_waitcnt lgkmcnt(10)
    v_mfma_f32_16x16x32_bf16 v[24:27], v[128:131], v[164:167], v[24:27]
    ds_read_b64_tr_b16 v[144:145], v222 offset:64
    s_waitcnt lgkmcnt(9)
    v_mfma_f32_16x16x32_bf16 v[28:31], v[128:131], v[168:171], v[28:31]
    ds_read_b64_tr_b16 v[146:147], v222 offset:3648
    s_waitcnt lgkmcnt(8)
    v_mfma_f32_16x16x32_bf16 v[32:35], v[132:135], v[156:159], v[32:35]
    ds_read_b64_tr_b16 v[176:177], v224 offset:34816
    ds_read_b64_tr_b16 v[178:179], v224 offset:35840
    v_mfma_f32_16x16x32_bf16 v[36:39], v[132:135], v[160:163], v[36:39]
    ds_read_b64_tr_b16 v[148:149], v222 offset:80
    v_mfma_f32_16x16x32_bf16 v[40:43], v[132:135], v[164:167], v[40:43]
    ds_read_b64_tr_b16 v[150:151], v222 offset:3664
    v_mfma_f32_16x16x32_bf16 v[44:47], v[132:135], v[168:171], v[44:47]
    ds_read_b64_tr_b16 v[180:181], v223 offset:38912
    s_waitcnt lgkmcnt(11)
    v_mfma_f32_16x16x32_bf16 v[48:51], v[136:139], v[156:159], v[48:51]
    ds_read_b64_tr_b16 v[182:183], v223 offset:39936
    ds_read_b64_tr_b16 v[152:153], v222 offset:96
    v_mfma_f32_16x16x32_bf16 v[52:55], v[136:139], v[160:163], v[52:55]
    ds_read_b64_tr_b16 v[154:155], v222 offset:3680
    v_mfma_f32_16x16x32_bf16 v[56:59], v[136:139], v[164:167], v[56:59]
    ds_read_b64_tr_b16 v[184:185], v224 offset:38912
    v_mfma_f32_16x16x32_bf16 v[60:63], v[136:139], v[168:171], v[60:63]
    ds_read_b64_tr_b16 v[186:187], v224 offset:39936
    s_waitcnt lgkmcnt(14)
    v_mfma_f32_16x16x32_bf16 v[64:67], v[140:143], v[156:159], v[64:67]
    ds_read_b64_tr_b16 v[128:129], v222 offset:7168
    ds_read_b64_tr_b16 v[130:131], v222 offset:10752
    v_mfma_f32_16x16x32_bf16 v[68:71], v[140:143], v[160:163], v[68:71]
    ds_read_b64_tr_b16 v[132:133], v222 offset:7184
    v_mfma_f32_16x16x32_bf16 v[72:75], v[140:143], v[164:167], v[72:75]
    ds_read_b64_tr_b16 v[134:135], v222 offset:10768
    v_mfma_f32_16x16x32_bf16 v[76:79], v[140:143], v[168:171], v[76:79]
    s_waitcnt lgkmcnt(14)
    v_mfma_f32_16x16x32_bf16 v[80:83], v[144:147], v[156:159], v[80:83]
    ds_read_b64_tr_b16 v[136:137], v222 offset:7200
    ds_read_b64_tr_b16 v[138:139], v222 offset:10784
    v_mfma_f32_16x16x32_bf16 v[84:87], v[144:147], v[160:163], v[84:87]
    v_mfma_f32_16x16x32_bf16 v[88:91], v[144:147], v[164:167], v[88:91]
    v_mfma_f32_16x16x32_bf16 v[92:95], v[144:147], v[168:171], v[92:95]
    s_waitcnt lgkmcnt(12)
    v_mfma_f32_16x16x32_bf16 v[96:99], v[148:151], v[156:159], v[96:99]
    ds_read_b64_tr_b16 v[140:141], v222 offset:7216
    ds_read_b64_tr_b16 v[142:143], v222 offset:10800
    v_mfma_f32_16x16x32_bf16 v[100:103], v[148:151], v[160:163], v[100:103]
    v_mfma_f32_16x16x32_bf16 v[104:107], v[148:151], v[164:167], v[104:107]
    v_mfma_f32_16x16x32_bf16 v[108:111], v[148:151], v[168:171], v[108:111]
    s_waitcnt lgkmcnt(10)
    v_mfma_f32_16x16x32_bf16 v[112:115], v[152:155], v[156:159], v[112:115]
    ds_read_b64_tr_b16 v[144:145], v222 offset:7232
    ds_read_b64_tr_b16 v[146:147], v222 offset:10816
    v_mfma_f32_16x16x32_bf16 v[116:119], v[152:155], v[160:163], v[116:119]
    v_mfma_f32_16x16x32_bf16 v[120:123], v[152:155], v[164:167], v[120:123]
    v_mfma_f32_16x16x32_bf16 v[124:127], v[152:155], v[168:171], v[124:127]
    s_waitcnt lgkmcnt(8)
    v_mfma_f32_16x16x32_bf16 v[16:19], v[128:131], v[172:175], v[16:19]
    ds_read_b64_tr_b16 v[148:149], v222 offset:7248
    ds_read_b64_tr_b16 v[150:151], v222 offset:10832
    v_mfma_f32_16x16x32_bf16 v[20:23], v[128:131], v[176:179], v[20:23]
    v_mfma_f32_16x16x32_bf16 v[24:27], v[128:131], v[180:183], v[24:27]
    v_mfma_f32_16x16x32_bf16 v[28:31], v[128:131], v[184:187], v[28:31]
    s_waitcnt lgkmcnt(8)
    v_mfma_f32_16x16x32_bf16 v[32:35], v[132:135], v[172:175], v[32:35]
    ds_read_b64_tr_b16 v[152:153], v222 offset:7264
    ds_read_b64_tr_b16 v[154:155], v222 offset:10848
    v_mfma_f32_16x16x32_bf16 v[36:39], v[132:135], v[176:179], v[36:39]
    v_mfma_f32_16x16x32_bf16 v[40:43], v[132:135], v[180:183], v[40:43]
    v_mfma_f32_16x16x32_bf16 v[44:47], v[132:135], v[184:187], v[44:47]
    s_waitcnt lgkmcnt(8)
    v_mfma_f32_16x16x32_bf16 v[48:51], v[136:139], v[172:175], v[48:51]
    v_mfma_f32_16x16x32_bf16 v[52:55], v[136:139], v[176:179], v[52:55]
    v_mfma_f32_16x16x32_bf16 v[56:59], v[136:139], v[180:183], v[56:59]
    v_mfma_f32_16x16x32_bf16 v[60:63], v[136:139], v[184:187], v[60:63]
    s_waitcnt lgkmcnt(6)
    v_mfma_f32_16x16x32_bf16 v[64:67], v[140:143], v[172:175], v[64:67]
    v_mfma_f32_16x16x32_bf16 v[68:71], v[140:143], v[176:179], v[68:71]
    v_mfma_f32_16x16x32_bf16 v[72:75], v[140:143], v[180:183], v[72:75]
    v_mfma_f32_16x16x32_bf16 v[76:79], v[140:143], v[184:187], v[76:79]
    s_waitcnt lgkmcnt(0)
    s_barrier
    v_mfma_f32_16x16x32_bf16 v[80:83], v[144:147], v[172:175], v[80:83]
    ds_read_b64_tr_b16 v[156:157], v223 offset:0
    ds_read_b64_tr_b16 v[158:159], v223 offset:1024
    v_mfma_f32_16x16x32_bf16 v[84:87], v[144:147], v[176:179], v[84:87]
    ds_read_b64_tr_b16 v[128:129], v220 offset:0
    v_mfma_f32_16x16x32_bf16 v[88:91], v[144:147], v[180:183], v[88:91]
    ds_read_b64_tr_b16 v[130:131], v220 offset:3584
    v_mfma_f32_16x16x32_bf16 v[92:95], v[144:147], v[184:187], v[92:95]
    ds_read_b64_tr_b16 v[160:161], v224 offset:0
    v_mfma_f32_16x16x32_bf16 v[96:99], v[148:151], v[172:175], v[96:99]
    ds_read_b64_tr_b16 v[162:163], v224 offset:1024
    ds_read_b64_tr_b16 v[164:165], v223 offset:4096
    v_mfma_f32_16x16x32_bf16 v[100:103], v[148:151], v[176:179], v[100:103]
    ds_read_b64_tr_b16 v[166:167], v223 offset:5120
    v_mfma_f32_16x16x32_bf16 v[104:107], v[148:151], v[180:183], v[104:107]
    ds_read_b64_tr_b16 v[168:169], v224 offset:4096
    v_mfma_f32_16x16x32_bf16 v[108:111], v[148:151], v[184:187], v[108:111]
    ds_read_b64_tr_b16 v[170:171], v224 offset:5120
    v_mfma_f32_16x16x32_bf16 v[112:115], v[152:155], v[172:175], v[112:115]
    ds_read_b64_tr_b16 v[132:133], v220 offset:16
    ds_read_b64_tr_b16 v[134:135], v220 offset:3600
    v_mfma_f32_16x16x32_bf16 v[116:119], v[152:155], v[176:179], v[116:119]
    ds_read_b64_tr_b16 v[136:137], v220 offset:32
    v_mfma_f32_16x16x32_bf16 v[120:123], v[152:155], v[180:183], v[120:123]
    ds_read_b64_tr_b16 v[138:139], v220 offset:3616
    v_mfma_f32_16x16x32_bf16 v[124:127], v[152:155], v[184:187], v[124:127]
    ds_read_b64_tr_b16 v[140:141], v220 offset:48
    s_waitcnt lgkmcnt(11)
    v_mfma_f32_16x16x32_bf16 v[16:19], v[128:131], v[156:159], v[16:19]
    ds_read_b64_tr_b16 v[142:143], v220 offset:3632
    ds_read_b64_tr_b16 v[172:173], v223 offset:2048
    s_waitcnt lgkmcnt(11)
    v_mfma_f32_16x16x32_bf16 v[20:23], v[128:131], v[160:163], v[20:23]
    ds_read_b64_tr_b16 v[174:175], v223 offset:3072
    s_waitcnt lgkmcnt(10)
    v_mfma_f32_16x16x32_bf16 v[24:27], v[128:131], v[164:167], v[24:27]
    ds_read_b64_tr_b16 v[144:145], v220 offset:64
    s_waitcnt lgkmcnt(9)
    v_mfma_f32_16x16x32_bf16 v[28:31], v[128:131], v[168:171], v[28:31]
    ds_read_b64_tr_b16 v[146:147], v220 offset:3648
    s_waitcnt lgkmcnt(8)
    v_mfma_f32_16x16x32_bf16 v[32:35], v[132:135], v[156:159], v[32:35]
    ds_read_b64_tr_b16 v[176:177], v224 offset:2048
    ds_read_b64_tr_b16 v[178:179], v224 offset:3072
    v_mfma_f32_16x16x32_bf16 v[36:39], v[132:135], v[160:163], v[36:39]
    ds_read_b64_tr_b16 v[148:149], v220 offset:80
    v_mfma_f32_16x16x32_bf16 v[40:43], v[132:135], v[164:167], v[40:43]
    ds_read_b64_tr_b16 v[150:151], v220 offset:3664
    v_mfma_f32_16x16x32_bf16 v[44:47], v[132:135], v[168:171], v[44:47]
    ds_read_b64_tr_b16 v[180:181], v223 offset:6144
    s_waitcnt lgkmcnt(11)
    v_mfma_f32_16x16x32_bf16 v[48:51], v[136:139], v[156:159], v[48:51]
    ds_read_b64_tr_b16 v[182:183], v223 offset:7168
    ds_read_b64_tr_b16 v[152:153], v220 offset:96
    v_mfma_f32_16x16x32_bf16 v[52:55], v[136:139], v[160:163], v[52:55]
    ds_read_b64_tr_b16 v[154:155], v220 offset:3680
    v_mfma_f32_16x16x32_bf16 v[56:59], v[136:139], v[164:167], v[56:59]
    ds_read_b64_tr_b16 v[184:185], v224 offset:6144
    v_mfma_f32_16x16x32_bf16 v[60:63], v[136:139], v[168:171], v[60:63]
    ds_read_b64_tr_b16 v[186:187], v224 offset:7168
    s_waitcnt lgkmcnt(14)
    v_mfma_f32_16x16x32_bf16 v[64:67], v[140:143], v[156:159], v[64:67]
    ds_read_b64_tr_b16 v[128:129], v220 offset:7168
    ds_read_b64_tr_b16 v[130:131], v220 offset:10752
    v_mfma_f32_16x16x32_bf16 v[68:71], v[140:143], v[160:163], v[68:71]
    ds_read_b64_tr_b16 v[132:133], v220 offset:7184
    v_mfma_f32_16x16x32_bf16 v[72:75], v[140:143], v[164:167], v[72:75]
    ds_read_b64_tr_b16 v[134:135], v220 offset:10768
    v_mfma_f32_16x16x32_bf16 v[76:79], v[140:143], v[168:171], v[76:79]
    s_waitcnt lgkmcnt(14)
    v_mfma_f32_16x16x32_bf16 v[80:83], v[144:147], v[156:159], v[80:83]
    ds_read_b64_tr_b16 v[136:137], v220 offset:7200
    ds_read_b64_tr_b16 v[138:139], v220 offset:10784
    v_mfma_f32_16x16x32_bf16 v[84:87], v[144:147], v[160:163], v[84:87]
    v_mfma_f32_16x16x32_bf16 v[88:91], v[144:147], v[164:167], v[88:91]
    v_mfma_f32_16x16x32_bf16 v[92:95], v[144:147], v[168:171], v[92:95]
    s_waitcnt lgkmcnt(12)
    v_mfma_f32_16x16x32_bf16 v[96:99], v[148:151], v[156:159], v[96:99]
    ds_read_b64_tr_b16 v[140:141], v220 offset:7216
    ds_read_b64_tr_b16 v[142:143], v220 offset:10800
    v_mfma_f32_16x16x32_bf16 v[100:103], v[148:151], v[160:163], v[100:103]
    v_mfma_f32_16x16x32_bf16 v[104:107], v[148:151], v[164:167], v[104:107]
    v_mfma_f32_16x16x32_bf16 v[108:111], v[148:151], v[168:171], v[108:111]
    s_waitcnt lgkmcnt(10)
    v_mfma_f32_16x16x32_bf16 v[112:115], v[152:155], v[156:159], v[112:115]
    ds_read_b64_tr_b16 v[144:145], v220 offset:7232
    ds_read_b64_tr_b16 v[146:147], v220 offset:10816
    v_mfma_f32_16x16x32_bf16 v[116:119], v[152:155], v[160:163], v[116:119]
    v_mfma_f32_16x16x32_bf16 v[120:123], v[152:155], v[164:167], v[120:123]
    v_mfma_f32_16x16x32_bf16 v[124:127], v[152:155], v[168:171], v[124:127]
    s_waitcnt lgkmcnt(8)
    v_mfma_f32_16x16x32_bf16 v[16:19], v[128:131], v[172:175], v[16:19]
    ds_read_b64_tr_b16 v[148:149], v220 offset:7248
    ds_read_b64_tr_b16 v[150:151], v220 offset:10832
    v_mfma_f32_16x16x32_bf16 v[20:23], v[128:131], v[176:179], v[20:23]
    v_mfma_f32_16x16x32_bf16 v[24:27], v[128:131], v[180:183], v[24:27]
    v_mfma_f32_16x16x32_bf16 v[28:31], v[128:131], v[184:187], v[28:31]
    s_waitcnt lgkmcnt(8)
    v_mfma_f32_16x16x32_bf16 v[32:35], v[132:135], v[172:175], v[32:35]
    ds_read_b64_tr_b16 v[152:153], v220 offset:7264
    ds_read_b64_tr_b16 v[154:155], v220 offset:10848
    v_mfma_f32_16x16x32_bf16 v[36:39], v[132:135], v[176:179], v[36:39]
    v_mfma_f32_16x16x32_bf16 v[40:43], v[132:135], v[180:183], v[40:43]
    v_mfma_f32_16x16x32_bf16 v[44:47], v[132:135], v[184:187], v[44:47]
    s_waitcnt lgkmcnt(8)
    v_mfma_f32_16x16x32_bf16 v[48:51], v[136:139], v[172:175], v[48:51]
    v_mfma_f32_16x16x32_bf16 v[52:55], v[136:139], v[176:179], v[52:55]
    v_mfma_f32_16x16x32_bf16 v[56:59], v[136:139], v[180:183], v[56:59]
    v_mfma_f32_16x16x32_bf16 v[60:63], v[136:139], v[184:187], v[60:63]
    s_waitcnt lgkmcnt(6)
    v_mfma_f32_16x16x32_bf16 v[64:67], v[140:143], v[172:175], v[64:67]
    v_mfma_f32_16x16x32_bf16 v[68:71], v[140:143], v[176:179], v[68:71]
    v_mfma_f32_16x16x32_bf16 v[72:75], v[140:143], v[180:183], v[72:75]
    v_mfma_f32_16x16x32_bf16 v[76:79], v[140:143], v[184:187], v[76:79]
    s_waitcnt lgkmcnt(0)
    s_barrier
    v_mfma_f32_16x16x32_bf16 v[80:83], v[144:147], v[172:175], v[80:83]
    ds_read_b64_tr_b16 v[156:157], v223 offset:16384
    ds_read_b64_tr_b16 v[158:159], v223 offset:17408
    v_mfma_f32_16x16x32_bf16 v[84:87], v[144:147], v[176:179], v[84:87]
    ds_read_b64_tr_b16 v[128:129], v221 offset:0
    v_mfma_f32_16x16x32_bf16 v[88:91], v[144:147], v[180:183], v[88:91]
    ds_read_b64_tr_b16 v[130:131], v221 offset:3584
    v_mfma_f32_16x16x32_bf16 v[92:95], v[144:147], v[184:187], v[92:95]
    ds_read_b64_tr_b16 v[160:161], v224 offset:16384
    v_mfma_f32_16x16x32_bf16 v[96:99], v[148:151], v[172:175], v[96:99]
    ds_read_b64_tr_b16 v[162:163], v224 offset:17408
    ds_read_b64_tr_b16 v[164:165], v223 offset:20480
    v_mfma_f32_16x16x32_bf16 v[100:103], v[148:151], v[176:179], v[100:103]
    ds_read_b64_tr_b16 v[166:167], v223 offset:21504
    v_mfma_f32_16x16x32_bf16 v[104:107], v[148:151], v[180:183], v[104:107]
    ds_read_b64_tr_b16 v[168:169], v224 offset:20480
    v_mfma_f32_16x16x32_bf16 v[108:111], v[148:151], v[184:187], v[108:111]
    ds_read_b64_tr_b16 v[170:171], v224 offset:21504
    v_mfma_f32_16x16x32_bf16 v[112:115], v[152:155], v[172:175], v[112:115]
    ds_read_b64_tr_b16 v[132:133], v221 offset:16
    ds_read_b64_tr_b16 v[134:135], v221 offset:3600
    v_mfma_f32_16x16x32_bf16 v[116:119], v[152:155], v[176:179], v[116:119]
    ds_read_b64_tr_b16 v[136:137], v221 offset:32
    v_mfma_f32_16x16x32_bf16 v[120:123], v[152:155], v[180:183], v[120:123]
    ds_read_b64_tr_b16 v[138:139], v221 offset:3616
    v_mfma_f32_16x16x32_bf16 v[124:127], v[152:155], v[184:187], v[124:127]
    ds_read_b64_tr_b16 v[140:141], v221 offset:48
    s_waitcnt lgkmcnt(11)
    v_mfma_f32_16x16x32_bf16 v[16:19], v[128:131], v[156:159], v[16:19]
    ds_read_b64_tr_b16 v[142:143], v221 offset:3632
    ds_read_b64_tr_b16 v[172:173], v223 offset:18432
    s_waitcnt lgkmcnt(11)
    v_mfma_f32_16x16x32_bf16 v[20:23], v[128:131], v[160:163], v[20:23]
    ds_read_b64_tr_b16 v[174:175], v223 offset:19456
    s_waitcnt lgkmcnt(10)
    v_mfma_f32_16x16x32_bf16 v[24:27], v[128:131], v[164:167], v[24:27]
    ds_read_b64_tr_b16 v[144:145], v221 offset:64
    s_waitcnt lgkmcnt(9)
    v_mfma_f32_16x16x32_bf16 v[28:31], v[128:131], v[168:171], v[28:31]
    ds_read_b64_tr_b16 v[146:147], v221 offset:3648
    s_waitcnt lgkmcnt(8)
    v_mfma_f32_16x16x32_bf16 v[32:35], v[132:135], v[156:159], v[32:35]
    ds_read_b64_tr_b16 v[176:177], v224 offset:18432
    ds_read_b64_tr_b16 v[178:179], v224 offset:19456
    v_mfma_f32_16x16x32_bf16 v[36:39], v[132:135], v[160:163], v[36:39]
    ds_read_b64_tr_b16 v[148:149], v221 offset:80
    v_mfma_f32_16x16x32_bf16 v[40:43], v[132:135], v[164:167], v[40:43]
    ds_read_b64_tr_b16 v[150:151], v221 offset:3664
    v_mfma_f32_16x16x32_bf16 v[44:47], v[132:135], v[168:171], v[44:47]
    ds_read_b64_tr_b16 v[180:181], v223 offset:22528
    s_waitcnt lgkmcnt(11)
    v_mfma_f32_16x16x32_bf16 v[48:51], v[136:139], v[156:159], v[48:51]
    ds_read_b64_tr_b16 v[182:183], v223 offset:23552
    ds_read_b64_tr_b16 v[152:153], v221 offset:96
    v_mfma_f32_16x16x32_bf16 v[52:55], v[136:139], v[160:163], v[52:55]
    ds_read_b64_tr_b16 v[154:155], v221 offset:3680
    v_mfma_f32_16x16x32_bf16 v[56:59], v[136:139], v[164:167], v[56:59]
    ds_read_b64_tr_b16 v[184:185], v224 offset:22528
    v_mfma_f32_16x16x32_bf16 v[60:63], v[136:139], v[168:171], v[60:63]
    ds_read_b64_tr_b16 v[186:187], v224 offset:23552
    s_waitcnt lgkmcnt(14)
    v_mfma_f32_16x16x32_bf16 v[64:67], v[140:143], v[156:159], v[64:67]
    ds_read_b64_tr_b16 v[128:129], v221 offset:7168
    ds_read_b64_tr_b16 v[130:131], v221 offset:10752
    v_mfma_f32_16x16x32_bf16 v[68:71], v[140:143], v[160:163], v[68:71]
    ds_read_b64_tr_b16 v[132:133], v221 offset:7184
    v_mfma_f32_16x16x32_bf16 v[72:75], v[140:143], v[164:167], v[72:75]
    ds_read_b64_tr_b16 v[134:135], v221 offset:10768
    v_mfma_f32_16x16x32_bf16 v[76:79], v[140:143], v[168:171], v[76:79]
    s_waitcnt lgkmcnt(14)
    v_mfma_f32_16x16x32_bf16 v[80:83], v[144:147], v[156:159], v[80:83]
    ds_read_b64_tr_b16 v[136:137], v221 offset:7200
    ds_read_b64_tr_b16 v[138:139], v221 offset:10784
    v_mfma_f32_16x16x32_bf16 v[84:87], v[144:147], v[160:163], v[84:87]
    v_mfma_f32_16x16x32_bf16 v[88:91], v[144:147], v[164:167], v[88:91]
    v_mfma_f32_16x16x32_bf16 v[92:95], v[144:147], v[168:171], v[92:95]
    s_waitcnt lgkmcnt(12)
    v_mfma_f32_16x16x32_bf16 v[96:99], v[148:151], v[156:159], v[96:99]
    ds_read_b64_tr_b16 v[140:141], v221 offset:7216
    ds_read_b64_tr_b16 v[142:143], v221 offset:10800
    v_mfma_f32_16x16x32_bf16 v[100:103], v[148:151], v[160:163], v[100:103]
    v_mfma_f32_16x16x32_bf16 v[104:107], v[148:151], v[164:167], v[104:107]
    v_mfma_f32_16x16x32_bf16 v[108:111], v[148:151], v[168:171], v[108:111]
    s_waitcnt lgkmcnt(10)
    v_mfma_f32_16x16x32_bf16 v[112:115], v[152:155], v[156:159], v[112:115]
    ds_read_b64_tr_b16 v[144:145], v221 offset:7232
    ds_read_b64_tr_b16 v[146:147], v221 offset:10816
    v_mfma_f32_16x16x32_bf16 v[116:119], v[152:155], v[160:163], v[116:119]
    v_mfma_f32_16x16x32_bf16 v[120:123], v[152:155], v[164:167], v[120:123]
    v_mfma_f32_16x16x32_bf16 v[124:127], v[152:155], v[168:171], v[124:127]
    s_waitcnt lgkmcnt(8)
    v_mfma_f32_16x16x32_bf16 v[16:19], v[128:131], v[172:175], v[16:19]
    ds_read_b64_tr_b16 v[148:149], v221 offset:7248
    ds_read_b64_tr_b16 v[150:151], v221 offset:10832
    v_mfma_f32_16x16x32_bf16 v[20:23], v[128:131], v[176:179], v[20:23]
    v_mfma_f32_16x16x32_bf16 v[24:27], v[128:131], v[180:183], v[24:27]
    v_mfma_f32_16x16x32_bf16 v[28:31], v[128:131], v[184:187], v[28:31]
    s_waitcnt lgkmcnt(8)
    v_mfma_f32_16x16x32_bf16 v[32:35], v[132:135], v[172:175], v[32:35]
    ds_read_b64_tr_b16 v[152:153], v221 offset:7264
    ds_read_b64_tr_b16 v[154:155], v221 offset:10848
    v_mfma_f32_16x16x32_bf16 v[36:39], v[132:135], v[176:179], v[36:39]
    v_mfma_f32_16x16x32_bf16 v[40:43], v[132:135], v[180:183], v[40:43]
    v_mfma_f32_16x16x32_bf16 v[44:47], v[132:135], v[184:187], v[44:47]
    s_waitcnt lgkmcnt(8)
    v_mfma_f32_16x16x32_bf16 v[48:51], v[136:139], v[172:175], v[48:51]
    v_mfma_f32_16x16x32_bf16 v[52:55], v[136:139], v[176:179], v[52:55]
    v_mfma_f32_16x16x32_bf16 v[56:59], v[136:139], v[180:183], v[56:59]
    v_mfma_f32_16x16x32_bf16 v[60:63], v[136:139], v[184:187], v[60:63]
    s_waitcnt lgkmcnt(6)
    v_mfma_f32_16x16x32_bf16 v[64:67], v[140:143], v[172:175], v[64:67]
    v_mfma_f32_16x16x32_bf16 v[68:71], v[140:143], v[176:179], v[68:71]
    v_mfma_f32_16x16x32_bf16 v[72:75], v[140:143], v[180:183], v[72:75]
    v_mfma_f32_16x16x32_bf16 v[76:79], v[140:143], v[184:187], v[76:79]
    s_waitcnt lgkmcnt(0)
    s_barrier
    v_mfma_f32_16x16x32_bf16 v[80:83], v[144:147], v[172:175], v[80:83]
    ds_read_b64_tr_b16 v[156:157], v223 offset:32768
    ds_read_b64_tr_b16 v[158:159], v223 offset:33792
    v_mfma_f32_16x16x32_bf16 v[84:87], v[144:147], v[176:179], v[84:87]
    ds_read_b64_tr_b16 v[128:129], v222 offset:0
    v_mfma_f32_16x16x32_bf16 v[88:91], v[144:147], v[180:183], v[88:91]
    ds_read_b64_tr_b16 v[130:131], v222 offset:3584
    v_mfma_f32_16x16x32_bf16 v[92:95], v[144:147], v[184:187], v[92:95]
    ds_read_b64_tr_b16 v[160:161], v224 offset:32768
    v_mfma_f32_16x16x32_bf16 v[96:99], v[148:151], v[172:175], v[96:99]
    ds_read_b64_tr_b16 v[162:163], v224 offset:33792
    ds_read_b64_tr_b16 v[164:165], v223 offset:36864
    v_mfma_f32_16x16x32_bf16 v[100:103], v[148:151], v[176:179], v[100:103]
    ds_read_b64_tr_b16 v[166:167], v223 offset:37888
    v_mfma_f32_16x16x32_bf16 v[104:107], v[148:151], v[180:183], v[104:107]
    ds_read_b64_tr_b16 v[168:169], v224 offset:36864
    v_mfma_f32_16x16x32_bf16 v[108:111], v[148:151], v[184:187], v[108:111]
    ds_read_b64_tr_b16 v[170:171], v224 offset:37888
    v_mfma_f32_16x16x32_bf16 v[112:115], v[152:155], v[172:175], v[112:115]
    ds_read_b64_tr_b16 v[132:133], v222 offset:16
    ds_read_b64_tr_b16 v[134:135], v222 offset:3600
    v_mfma_f32_16x16x32_bf16 v[116:119], v[152:155], v[176:179], v[116:119]
    ds_read_b64_tr_b16 v[136:137], v222 offset:32
    v_mfma_f32_16x16x32_bf16 v[120:123], v[152:155], v[180:183], v[120:123]
    ds_read_b64_tr_b16 v[138:139], v222 offset:3616
    v_mfma_f32_16x16x32_bf16 v[124:127], v[152:155], v[184:187], v[124:127]
    ds_read_b64_tr_b16 v[140:141], v222 offset:48
    s_waitcnt lgkmcnt(11)
    v_mfma_f32_16x16x32_bf16 v[16:19], v[128:131], v[156:159], v[16:19]
    ds_read_b64_tr_b16 v[142:143], v222 offset:3632
    ds_read_b64_tr_b16 v[172:173], v223 offset:34816
    s_waitcnt lgkmcnt(11)
    v_mfma_f32_16x16x32_bf16 v[20:23], v[128:131], v[160:163], v[20:23]
    ds_read_b64_tr_b16 v[174:175], v223 offset:35840
    s_waitcnt lgkmcnt(10)
    v_mfma_f32_16x16x32_bf16 v[24:27], v[128:131], v[164:167], v[24:27]
    ds_read_b64_tr_b16 v[144:145], v222 offset:64
    s_waitcnt lgkmcnt(9)
    v_mfma_f32_16x16x32_bf16 v[28:31], v[128:131], v[168:171], v[28:31]
    ds_read_b64_tr_b16 v[146:147], v222 offset:3648
    s_waitcnt lgkmcnt(8)
    v_mfma_f32_16x16x32_bf16 v[32:35], v[132:135], v[156:159], v[32:35]
    ds_read_b64_tr_b16 v[176:177], v224 offset:34816
    ds_read_b64_tr_b16 v[178:179], v224 offset:35840
    v_mfma_f32_16x16x32_bf16 v[36:39], v[132:135], v[160:163], v[36:39]
    ds_read_b64_tr_b16 v[148:149], v222 offset:80
    v_mfma_f32_16x16x32_bf16 v[40:43], v[132:135], v[164:167], v[40:43]
    ds_read_b64_tr_b16 v[150:151], v222 offset:3664
    v_mfma_f32_16x16x32_bf16 v[44:47], v[132:135], v[168:171], v[44:47]
    ds_read_b64_tr_b16 v[180:181], v223 offset:38912
    s_waitcnt lgkmcnt(11)
    v_mfma_f32_16x16x32_bf16 v[48:51], v[136:139], v[156:159], v[48:51]
    ds_read_b64_tr_b16 v[182:183], v223 offset:39936
    ds_read_b64_tr_b16 v[152:153], v222 offset:96
    v_mfma_f32_16x16x32_bf16 v[52:55], v[136:139], v[160:163], v[52:55]
    ds_read_b64_tr_b16 v[154:155], v222 offset:3680
    v_mfma_f32_16x16x32_bf16 v[56:59], v[136:139], v[164:167], v[56:59]
    ds_read_b64_tr_b16 v[184:185], v224 offset:38912
    v_mfma_f32_16x16x32_bf16 v[60:63], v[136:139], v[168:171], v[60:63]
    ds_read_b64_tr_b16 v[186:187], v224 offset:39936
    s_waitcnt lgkmcnt(14)
    v_mfma_f32_16x16x32_bf16 v[64:67], v[140:143], v[156:159], v[64:67]
    ds_read_b64_tr_b16 v[128:129], v222 offset:7168
    ds_read_b64_tr_b16 v[130:131], v222 offset:10752
    v_mfma_f32_16x16x32_bf16 v[68:71], v[140:143], v[160:163], v[68:71]
    ds_read_b64_tr_b16 v[132:133], v222 offset:7184
    v_mfma_f32_16x16x32_bf16 v[72:75], v[140:143], v[164:167], v[72:75]
    ds_read_b64_tr_b16 v[134:135], v222 offset:10768
    v_mfma_f32_16x16x32_bf16 v[76:79], v[140:143], v[168:171], v[76:79]
    s_waitcnt lgkmcnt(14)
    v_mfma_f32_16x16x32_bf16 v[80:83], v[144:147], v[156:159], v[80:83]
    ds_read_b64_tr_b16 v[136:137], v222 offset:7200
    ds_read_b64_tr_b16 v[138:139], v222 offset:10784
    v_mfma_f32_16x16x32_bf16 v[84:87], v[144:147], v[160:163], v[84:87]
    v_mfma_f32_16x16x32_bf16 v[88:91], v[144:147], v[164:167], v[88:91]
    v_mfma_f32_16x16x32_bf16 v[92:95], v[144:147], v[168:171], v[92:95]
    s_waitcnt lgkmcnt(12)
    v_mfma_f32_16x16x32_bf16 v[96:99], v[148:151], v[156:159], v[96:99]
    ds_read_b64_tr_b16 v[140:141], v222 offset:7216
    ds_read_b64_tr_b16 v[142:143], v222 offset:10800
    v_mfma_f32_16x16x32_bf16 v[100:103], v[148:151], v[160:163], v[100:103]
    v_mfma_f32_16x16x32_bf16 v[104:107], v[148:151], v[164:167], v[104:107]
    v_mfma_f32_16x16x32_bf16 v[108:111], v[148:151], v[168:171], v[108:111]
    s_waitcnt lgkmcnt(10)
    v_mfma_f32_16x16x32_bf16 v[112:115], v[152:155], v[156:159], v[112:115]
    ds_read_b64_tr_b16 v[144:145], v222 offset:7232
    ds_read_b64_tr_b16 v[146:147], v222 offset:10816
    v_mfma_f32_16x16x32_bf16 v[116:119], v[152:155], v[160:163], v[116:119]
    v_mfma_f32_16x16x32_bf16 v[120:123], v[152:155], v[164:167], v[120:123]
    v_mfma_f32_16x16x32_bf16 v[124:127], v[152:155], v[168:171], v[124:127]
    s_waitcnt lgkmcnt(8)
    v_mfma_f32_16x16x32_bf16 v[16:19], v[128:131], v[172:175], v[16:19]
    ds_read_b64_tr_b16 v[148:149], v222 offset:7248
    ds_read_b64_tr_b16 v[150:151], v222 offset:10832
    v_mfma_f32_16x16x32_bf16 v[20:23], v[128:131], v[176:179], v[20:23]
    v_mfma_f32_16x16x32_bf16 v[24:27], v[128:131], v[180:183], v[24:27]
    v_mfma_f32_16x16x32_bf16 v[28:31], v[128:131], v[184:187], v[28:31]
    s_waitcnt lgkmcnt(8)
    v_mfma_f32_16x16x32_bf16 v[32:35], v[132:135], v[172:175], v[32:35]
    ds_read_b64_tr_b16 v[152:153], v222 offset:7264
    ds_read_b64_tr_b16 v[154:155], v222 offset:10848
    v_mfma_f32_16x16x32_bf16 v[36:39], v[132:135], v[176:179], v[36:39]
    v_mfma_f32_16x16x32_bf16 v[40:43], v[132:135], v[180:183], v[40:43]
    v_mfma_f32_16x16x32_bf16 v[44:47], v[132:135], v[184:187], v[44:47]
    s_waitcnt lgkmcnt(8)
    v_mfma_f32_16x16x32_bf16 v[48:51], v[136:139], v[172:175], v[48:51]
    v_mfma_f32_16x16x32_bf16 v[52:55], v[136:139], v[176:179], v[52:55]
    v_mfma_f32_16x16x32_bf16 v[56:59], v[136:139], v[180:183], v[56:59]
    v_mfma_f32_16x16x32_bf16 v[60:63], v[136:139], v[184:187], v[60:63]
    s_waitcnt lgkmcnt(6)
    v_mfma_f32_16x16x32_bf16 v[64:67], v[140:143], v[172:175], v[64:67]
    v_mfma_f32_16x16x32_bf16 v[68:71], v[140:143], v[176:179], v[68:71]
    v_mfma_f32_16x16x32_bf16 v[72:75], v[140:143], v[180:183], v[72:75]
    v_mfma_f32_16x16x32_bf16 v[76:79], v[140:143], v[184:187], v[76:79]
    s_waitcnt lgkmcnt(0)
    s_barrier
    v_mfma_f32_16x16x32_bf16 v[80:83], v[144:147], v[172:175], v[80:83]
    ds_read_b64_tr_b16 v[156:157], v223 offset:0
    ds_read_b64_tr_b16 v[158:159], v223 offset:1024
    v_mfma_f32_16x16x32_bf16 v[84:87], v[144:147], v[176:179], v[84:87]
    ds_read_b64_tr_b16 v[128:129], v220 offset:0
    v_mfma_f32_16x16x32_bf16 v[88:91], v[144:147], v[180:183], v[88:91]
    ds_read_b64_tr_b16 v[130:131], v220 offset:3584
    v_mfma_f32_16x16x32_bf16 v[92:95], v[144:147], v[184:187], v[92:95]
    ds_read_b64_tr_b16 v[160:161], v224 offset:0
    v_mfma_f32_16x16x32_bf16 v[96:99], v[148:151], v[172:175], v[96:99]
    ds_read_b64_tr_b16 v[162:163], v224 offset:1024
    ds_read_b64_tr_b16 v[164:165], v223 offset:4096
    v_mfma_f32_16x16x32_bf16 v[100:103], v[148:151], v[176:179], v[100:103]
    ds_read_b64_tr_b16 v[166:167], v223 offset:5120
    v_mfma_f32_16x16x32_bf16 v[104:107], v[148:151], v[180:183], v[104:107]
    ds_read_b64_tr_b16 v[168:169], v224 offset:4096
    v_mfma_f32_16x16x32_bf16 v[108:111], v[148:151], v[184:187], v[108:111]
    ds_read_b64_tr_b16 v[170:171], v224 offset:5120
    v_mfma_f32_16x16x32_bf16 v[112:115], v[152:155], v[172:175], v[112:115]
    ds_read_b64_tr_b16 v[132:133], v220 offset:16
    ds_read_b64_tr_b16 v[134:135], v220 offset:3600
    v_mfma_f32_16x16x32_bf16 v[116:119], v[152:155], v[176:179], v[116:119]
    ds_read_b64_tr_b16 v[136:137], v220 offset:32
    v_mfma_f32_16x16x32_bf16 v[120:123], v[152:155], v[180:183], v[120:123]
    ds_read_b64_tr_b16 v[138:139], v220 offset:3616
    v_mfma_f32_16x16x32_bf16 v[124:127], v[152:155], v[184:187], v[124:127]
    ds_read_b64_tr_b16 v[140:141], v220 offset:48
    s_waitcnt lgkmcnt(11)
    v_mfma_f32_16x16x32_bf16 v[16:19], v[128:131], v[156:159], v[16:19]
    ds_read_b64_tr_b16 v[142:143], v220 offset:3632
    ds_read_b64_tr_b16 v[172:173], v223 offset:2048
    s_waitcnt lgkmcnt(11)
    v_mfma_f32_16x16x32_bf16 v[20:23], v[128:131], v[160:163], v[20:23]
    ds_read_b64_tr_b16 v[174:175], v223 offset:3072
    s_waitcnt lgkmcnt(10)
    v_mfma_f32_16x16x32_bf16 v[24:27], v[128:131], v[164:167], v[24:27]
    ds_read_b64_tr_b16 v[144:145], v220 offset:64
    s_waitcnt lgkmcnt(9)
    v_mfma_f32_16x16x32_bf16 v[28:31], v[128:131], v[168:171], v[28:31]
    ds_read_b64_tr_b16 v[146:147], v220 offset:3648
    s_waitcnt lgkmcnt(8)
    v_mfma_f32_16x16x32_bf16 v[32:35], v[132:135], v[156:159], v[32:35]
    ds_read_b64_tr_b16 v[176:177], v224 offset:2048
    ds_read_b64_tr_b16 v[178:179], v224 offset:3072
    v_mfma_f32_16x16x32_bf16 v[36:39], v[132:135], v[160:163], v[36:39]
    ds_read_b64_tr_b16 v[148:149], v220 offset:80
    v_mfma_f32_16x16x32_bf16 v[40:43], v[132:135], v[164:167], v[40:43]
    ds_read_b64_tr_b16 v[150:151], v220 offset:3664
    v_mfma_f32_16x16x32_bf16 v[44:47], v[132:135], v[168:171], v[44:47]
    ds_read_b64_tr_b16 v[180:181], v223 offset:6144
    s_waitcnt lgkmcnt(11)
    v_mfma_f32_16x16x32_bf16 v[48:51], v[136:139], v[156:159], v[48:51]
    ds_read_b64_tr_b16 v[182:183], v223 offset:7168
    ds_read_b64_tr_b16 v[152:153], v220 offset:96
    v_mfma_f32_16x16x32_bf16 v[52:55], v[136:139], v[160:163], v[52:55]
    ds_read_b64_tr_b16 v[154:155], v220 offset:3680
    v_mfma_f32_16x16x32_bf16 v[56:59], v[136:139], v[164:167], v[56:59]
    ds_read_b64_tr_b16 v[184:185], v224 offset:6144
    v_mfma_f32_16x16x32_bf16 v[60:63], v[136:139], v[168:171], v[60:63]
    ds_read_b64_tr_b16 v[186:187], v224 offset:7168
    s_waitcnt lgkmcnt(14)
    v_mfma_f32_16x16x32_bf16 v[64:67], v[140:143], v[156:159], v[64:67]
    ds_read_b64_tr_b16 v[128:129], v220 offset:7168
    ds_read_b64_tr_b16 v[130:131], v220 offset:10752
    v_mfma_f32_16x16x32_bf16 v[68:71], v[140:143], v[160:163], v[68:71]
    ds_read_b64_tr_b16 v[132:133], v220 offset:7184
    v_mfma_f32_16x16x32_bf16 v[72:75], v[140:143], v[164:167], v[72:75]
    ds_read_b64_tr_b16 v[134:135], v220 offset:10768
    v_mfma_f32_16x16x32_bf16 v[76:79], v[140:143], v[168:171], v[76:79]
    s_waitcnt lgkmcnt(14)
    v_mfma_f32_16x16x32_bf16 v[80:83], v[144:147], v[156:159], v[80:83]
    ds_read_b64_tr_b16 v[136:137], v220 offset:7200
    ds_read_b64_tr_b16 v[138:139], v220 offset:10784
    v_mfma_f32_16x16x32_bf16 v[84:87], v[144:147], v[160:163], v[84:87]
    v_mfma_f32_16x16x32_bf16 v[88:91], v[144:147], v[164:167], v[88:91]
    v_mfma_f32_16x16x32_bf16 v[92:95], v[144:147], v[168:171], v[92:95]
    s_waitcnt lgkmcnt(12)
    v_mfma_f32_16x16x32_bf16 v[96:99], v[148:151], v[156:159], v[96:99]
    ds_read_b64_tr_b16 v[140:141], v220 offset:7216
    ds_read_b64_tr_b16 v[142:143], v220 offset:10800
    v_mfma_f32_16x16x32_bf16 v[100:103], v[148:151], v[160:163], v[100:103]
    v_mfma_f32_16x16x32_bf16 v[104:107], v[148:151], v[164:167], v[104:107]
    v_mfma_f32_16x16x32_bf16 v[108:111], v[148:151], v[168:171], v[108:111]
    s_waitcnt lgkmcnt(10)
    v_mfma_f32_16x16x32_bf16 v[112:115], v[152:155], v[156:159], v[112:115]
    ds_read_b64_tr_b16 v[144:145], v220 offset:7232
    ds_read_b64_tr_b16 v[146:147], v220 offset:10816
    v_mfma_f32_16x16x32_bf16 v[116:119], v[152:155], v[160:163], v[116:119]
    v_mfma_f32_16x16x32_bf16 v[120:123], v[152:155], v[164:167], v[120:123]
    v_mfma_f32_16x16x32_bf16 v[124:127], v[152:155], v[168:171], v[124:127]
    s_waitcnt lgkmcnt(8)
    v_mfma_f32_16x16x32_bf16 v[16:19], v[128:131], v[172:175], v[16:19]
    ds_read_b64_tr_b16 v[148:149], v220 offset:7248
    ds_read_b64_tr_b16 v[150:151], v220 offset:10832
    v_mfma_f32_16x16x32_bf16 v[20:23], v[128:131], v[176:179], v[20:23]
    v_mfma_f32_16x16x32_bf16 v[24:27], v[128:131], v[180:183], v[24:27]
    v_mfma_f32_16x16x32_bf16 v[28:31], v[128:131], v[184:187], v[28:31]
    s_waitcnt lgkmcnt(8)
    v_mfma_f32_16x16x32_bf16 v[32:35], v[132:135], v[172:175], v[32:35]
    ds_read_b64_tr_b16 v[152:153], v220 offset:7264
    ds_read_b64_tr_b16 v[154:155], v220 offset:10848
    v_mfma_f32_16x16x32_bf16 v[36:39], v[132:135], v[176:179], v[36:39]
    v_mfma_f32_16x16x32_bf16 v[40:43], v[132:135], v[180:183], v[40:43]
    v_mfma_f32_16x16x32_bf16 v[44:47], v[132:135], v[184:187], v[44:47]
    s_waitcnt lgkmcnt(8)
    v_mfma_f32_16x16x32_bf16 v[48:51], v[136:139], v[172:175], v[48:51]
    v_mfma_f32_16x16x32_bf16 v[52:55], v[136:139], v[176:179], v[52:55]
    v_mfma_f32_16x16x32_bf16 v[56:59], v[136:139], v[180:183], v[56:59]
    v_mfma_f32_16x16x32_bf16 v[60:63], v[136:139], v[184:187], v[60:63]
    s_waitcnt lgkmcnt(6)
    v_mfma_f32_16x16x32_bf16 v[64:67], v[140:143], v[172:175], v[64:67]
    v_mfma_f32_16x16x32_bf16 v[68:71], v[140:143], v[176:179], v[68:71]
    v_mfma_f32_16x16x32_bf16 v[72:75], v[140:143], v[180:183], v[72:75]
    v_mfma_f32_16x16x32_bf16 v[76:79], v[140:143], v[184:187], v[76:79]
    s_waitcnt lgkmcnt(0)
    s_barrier
    v_mfma_f32_16x16x32_bf16 v[80:83], v[144:147], v[172:175], v[80:83]
    ds_read_b64_tr_b16 v[156:157], v223 offset:16384
    ds_read_b64_tr_b16 v[158:159], v223 offset:17408
    v_mfma_f32_16x16x32_bf16 v[84:87], v[144:147], v[176:179], v[84:87]
    ds_read_b64_tr_b16 v[128:129], v221 offset:0
    ds_read_b64_tr_b16 v[130:131], v221 offset:3584
    v_mfma_f32_16x16x32_bf16 v[88:91], v[144:147], v[180:183], v[88:91]
    ds_read_b64_tr_b16 v[160:161], v224 offset:16384
    ds_read_b64_tr_b16 v[162:163], v224 offset:17408
    v_mfma_f32_16x16x32_bf16 v[92:95], v[144:147], v[184:187], v[92:95]
    ds_read_b64_tr_b16 v[164:165], v223 offset:20480
    ds_read_b64_tr_b16 v[166:167], v223 offset:21504
    v_mfma_f32_16x16x32_bf16 v[96:99], v[148:151], v[172:175], v[96:99]
    ds_read_b64_tr_b16 v[168:169], v224 offset:20480
    ds_read_b64_tr_b16 v[170:171], v224 offset:21504
    v_mfma_f32_16x16x32_bf16 v[100:103], v[148:151], v[176:179], v[100:103]
    ds_read_b64_tr_b16 v[132:133], v221 offset:16
    ds_read_b64_tr_b16 v[134:135], v221 offset:3600
    v_mfma_f32_16x16x32_bf16 v[104:107], v[148:151], v[180:183], v[104:107]
    ds_read_b64_tr_b16 v[136:137], v221 offset:32
    ds_read_b64_tr_b16 v[138:139], v221 offset:3616
    v_mfma_f32_16x16x32_bf16 v[108:111], v[148:151], v[184:187], v[108:111]
    ds_read_b64_tr_b16 v[140:141], v221 offset:48
    ds_read_b64_tr_b16 v[142:143], v221 offset:3632
    v_mfma_f32_16x16x32_bf16 v[112:115], v[152:155], v[172:175], v[112:115]
    v_mfma_f32_16x16x32_bf16 v[116:119], v[152:155], v[176:179], v[116:119]
    v_mfma_f32_16x16x32_bf16 v[120:123], v[152:155], v[180:183], v[120:123]
    v_mfma_f32_16x16x32_bf16 v[124:127], v[152:155], v[184:187], v[124:127]
    s_waitcnt lgkmcnt(12)
    v_mfma_f32_16x16x32_bf16 v[16:19], v[128:131], v[156:159], v[16:19]
    ds_read_b64_tr_b16 v[172:173], v223 offset:18432
    ds_read_b64_tr_b16 v[174:175], v223 offset:19456
    s_waitcnt lgkmcnt(12)
    v_mfma_f32_16x16x32_bf16 v[20:23], v[128:131], v[160:163], v[20:23]
    ds_read_b64_tr_b16 v[144:145], v221 offset:64
    ds_read_b64_tr_b16 v[146:147], v221 offset:3648
    s_waitcnt lgkmcnt(12)
    v_mfma_f32_16x16x32_bf16 v[24:27], v[128:131], v[164:167], v[24:27]
    ds_read_b64_tr_b16 v[176:177], v224 offset:18432
    ds_read_b64_tr_b16 v[178:179], v224 offset:19456
    s_waitcnt lgkmcnt(12)
    v_mfma_f32_16x16x32_bf16 v[28:31], v[128:131], v[168:171], v[28:31]
    ds_read_b64 v[202:203], v231 offset:0
    ds_read_b64 v[204:205], v231 offset:128
    s_waitcnt lgkmcnt(12)
    v_mfma_f32_16x16x32_bf16 v[32:35], v[132:135], v[156:159], v[32:35]
    ds_read_b64 v[206:207], v231 offset:256
    ds_read_b64 v[208:209], v231 offset:384
    v_mfma_f32_16x16x32_bf16 v[36:39], v[132:135], v[160:163], v[36:39]
    ds_read_b64_tr_b16 v[148:149], v221 offset:80
    ds_read_b64_tr_b16 v[150:151], v221 offset:3664
    v_mfma_f32_16x16x32_bf16 v[40:43], v[132:135], v[164:167], v[40:43]
    ds_read_b64_tr_b16 v[180:181], v223 offset:22528
    ds_read_b64_tr_b16 v[182:183], v223 offset:23552
    v_mfma_f32_16x16x32_bf16 v[44:47], v[132:135], v[168:171], v[44:47]
    ds_read_b64 v[210:211], v219 offset:1024
    ds_read_b64 v[212:213], v219 offset:1280
    s_waitcnt lgkmcnt(15)
    v_mfma_f32_16x16x32_bf16 v[48:51], v[136:139], v[156:159], v[48:51]
    ds_read_b32 v188, v230 offset:0
    ds_read_b32 v189, v230 offset:896
    v_mfma_f32_16x16x32_bf16 v[52:55], v[136:139], v[160:163], v[52:55]
    ds_read_b64_tr_b16 v[152:153], v221 offset:96
    ds_read_b64_tr_b16 v[154:155], v221 offset:3680
    v_mfma_f32_16x16x32_bf16 v[56:59], v[136:139], v[164:167], v[56:59]
    ds_read_b64_tr_b16 v[184:185], v224 offset:22528
    ds_read_b64_tr_b16 v[186:187], v224 offset:23552
    v_mfma_f32_16x16x32_bf16 v[60:63], v[136:139], v[168:171], v[60:63]
    ds_read_b32 v190, v230 offset:32
    ds_read_b32 v191, v230 offset:928
    v_mfma_f32_16x16x32_bf16 v[64:67], v[140:143], v[156:159], v[64:67]
    ds_read_b32 v192, v230 offset:64
    ds_read_b32 v193, v230 offset:960
    v_mfma_f32_16x16x32_bf16 v[68:71], v[140:143], v[160:163], v[68:71]
    ds_read_b64_tr_b16 v[128:129], v221 offset:7168
    ds_read_b64_tr_b16 v[130:131], v221 offset:10752
    v_mfma_f32_16x16x32_bf16 v[72:75], v[140:143], v[164:167], v[72:75]
    ds_read_b32 v194, v230 offset:96
    ds_read_b32 v195, v230 offset:992
    v_mfma_f32_16x16x32_bf16 v[76:79], v[140:143], v[168:171], v[76:79]
    ds_read_b32 v196, v230 offset:128
    ds_read_b32 v197, v230 offset:1024
    s_waitcnt lgkmcnt(15)
    v_mfma_f32_16x16x32_bf16 v[80:83], v[144:147], v[156:159], v[80:83]
    ds_read_b64_tr_b16 v[132:133], v221 offset:7184
    ds_read_b64_tr_b16 v[134:135], v221 offset:10768
    v_mfma_f32_16x16x32_bf16 v[84:87], v[144:147], v[160:163], v[84:87]
    ds_read_b32 v198, v230 offset:160
    ds_read_b32 v199, v230 offset:1056
    v_mfma_f32_16x16x32_bf16 v[88:91], v[144:147], v[164:167], v[88:91]
    ds_read_b32 v200, v230 offset:192
    ds_read_b32 v201, v230 offset:1088
    v_mfma_f32_16x16x32_bf16 v[92:95], v[144:147], v[168:171], v[92:95]
    ds_read_b64_tr_b16 v[136:137], v221 offset:7200
    ds_read_b64_tr_b16 v[138:139], v221 offset:10784
    v_mfma_f32_16x16x32_bf16 v[96:99], v[148:151], v[156:159], v[96:99]
    ds_read_b64_tr_b16 v[140:141], v221 offset:7216
    ds_read_b64_tr_b16 v[142:143], v221 offset:10800
    v_mfma_f32_16x16x32_bf16 v[100:103], v[148:151], v[160:163], v[100:103]
    v_mfma_f32_16x16x32_bf16 v[104:107], v[148:151], v[164:167], v[104:107]
    v_mfma_f32_16x16x32_bf16 v[108:111], v[148:151], v[168:171], v[108:111]
    s_waitcnt lgkmcnt(15)
    v_mfma_f32_16x16x32_bf16 v[112:115], v[152:155], v[156:159], v[112:115]
    ds_read_b64_tr_b16 v[144:145], v221 offset:7232
    ds_read_b64_tr_b16 v[146:147], v221 offset:10816
    v_mfma_f32_16x16x32_bf16 v[116:119], v[152:155], v[160:163], v[116:119]
    v_mfma_f32_16x16x32_bf16 v[120:123], v[152:155], v[164:167], v[120:123]
    v_mfma_f32_16x16x32_bf16 v[124:127], v[152:155], v[168:171], v[124:127]
    ds_read_b64_tr_b16 v[148:149], v221 offset:7248
    ds_read_b64_tr_b16 v[150:151], v221 offset:10832
    s_waitcnt lgkmcnt(15)
    v_mfma_f32_16x16x32_bf16 v[16:19], v[128:131], v[172:175], v[16:19]
    v_mfma_f32_16x16x32_bf16 v[20:23], v[128:131], v[176:179], v[20:23]
    v_mfma_f32_16x16x32_bf16 v[24:27], v[128:131], v[180:183], v[24:27]
    v_mfma_f32_16x16x32_bf16 v[28:31], v[128:131], v[184:187], v[28:31]
    s_waitcnt lgkmcnt(8)
    v_mfma_f32_16x16x16_bf16 v[16:19], v[188:189], v[202:203], v[16:19]
    v_mfma_f32_16x16x16_bf16 v[20:23], v[188:189], v[204:205], v[20:23]
    v_mfma_f32_16x16x16_bf16 v[24:27], v[188:189], v[206:207], v[24:27]
    v_mfma_f32_16x16x16_bf16 v[28:31], v[188:189], v[208:209], v[28:31]
    s_nop 5
    v_permlane16_swap_b32 v16, v20
    v_permlane16_swap_b32 v17, v21
    v_permlane16_swap_b32 v18, v22
    v_permlane16_swap_b32 v19, v23
    v_permlane16_swap_b32 v24, v28
    v_permlane16_swap_b32 v25, v29
    v_permlane16_swap_b32 v26, v30
    v_permlane16_swap_b32 v27, v31
    v_pk_mul_f32 v[232:233], v[16:17], v[210:211] op_sel:[0,0] op_sel_hi:[1,0]
    v_pk_mul_f32 v[234:235], v[18:19], v[210:211] op_sel:[0,0] op_sel_hi:[1,0]
    v_pk_mul_f32 v[236:237], v[24:25], v[212:213] op_sel:[0,0] op_sel_hi:[1,0]
    v_pk_mul_f32 v[238:239], v[26:27], v[212:213] op_sel:[0,0] op_sel_hi:[1,0]
    v_pk_mul_f32 v[16:17], v[16:17], v[20:21]
    v_pk_mul_f32 v[18:19], v[18:19], v[22:23]
    v_pk_mul_f32 v[24:25], v[24:25], v[28:29]
    v_pk_mul_f32 v[26:27], v[26:27], v[30:31]
    ds_read_b64_tr_b16 v[152:153], v221 offset:7264
    ds_read_b64_tr_b16 v[154:155], v221 offset:10848
    v_mfma_f32_16x16x32_bf16 v[32:35], v[132:135], v[172:175], v[32:35]
    v_exp_f32 v232, v232
    v_exp_f32 v233, v233
    v_mfma_f32_16x16x32_bf16 v[36:39], v[132:135], v[176:179], v[36:39]
    v_exp_f32 v234, v234
    v_exp_f32 v235, v235
    v_mfma_f32_16x16x32_bf16 v[40:43], v[132:135], v[180:183], v[40:43]
    v_exp_f32 v236, v236
    v_exp_f32 v237, v237
    v_mfma_f32_16x16x32_bf16 v[44:47], v[132:135], v[184:187], v[44:47]
    v_exp_f32 v238, v238
    v_exp_f32 v239, v239
    v_pk_fma_f32 v[232:233], v[232:233], v[210:211], v[210:211] op_sel:[0,1,1] op_sel_hi:[1,1,1]
    v_pk_fma_f32 v[234:235], v[234:235], v[210:211], v[210:211] op_sel:[0,1,1] op_sel_hi:[1,1,1]
    v_pk_fma_f32 v[236:237], v[236:237], v[212:213], v[212:213] op_sel:[0,1,1] op_sel_hi:[1,1,1]
    v_pk_fma_f32 v[238:239], v[238:239], v[212:213], v[212:213] op_sel:[0,1,1] op_sel_hi:[1,1,1]
    v_mfma_f32_16x16x16_bf16 v[32:35], v[190:191], v[202:203], v[32:35]
    v_rcp_f32 v232, v232
    v_rcp_f32 v233, v233
    v_mfma_f32_16x16x16_bf16 v[36:39], v[190:191], v[204:205], v[36:39]
    v_rcp_f32 v234, v234
    v_rcp_f32 v235, v235
    v_mfma_f32_16x16x16_bf16 v[40:43], v[190:191], v[206:207], v[40:43]
    v_rcp_f32 v236, v236
    v_rcp_f32 v237, v237
    v_mfma_f32_16x16x16_bf16 v[44:47], v[190:191], v[208:209], v[44:47]
    v_rcp_f32 v238, v238
    v_rcp_f32 v239, v239
    v_pk_mul_f32 v[16:17], v[16:17], v[232:233]
    v_pk_mul_f32 v[18:19], v[18:19], v[234:235]
    v_pk_mul_f32 v[24:25], v[24:25], v[236:237]
    v_pk_mul_f32 v[26:27], v[26:27], v[238:239]
    v_cvt_pk_bf16_f32 v8, v16, v17
    v_cvt_pk_bf16_f32 v9, v18, v19
    v_cvt_pk_bf16_f32 v10, v24, v25
    v_cvt_pk_bf16_f32 v11, v26, v27
    s_nop 0
    v_permlane32_swap_b32 v8, v10
    v_permlane32_swap_b32 v9, v11
    buffer_store_dwordx4 v[8:11], v218, s[8:11], s41 offen offset:0 sc1
    v_permlane16_swap_b32 v32, v36
    v_permlane16_swap_b32 v33, v37
    v_permlane16_swap_b32 v34, v38
    v_permlane16_swap_b32 v35, v39
    v_permlane16_swap_b32 v40, v44
    v_permlane16_swap_b32 v41, v45
    v_permlane16_swap_b32 v42, v46
    v_permlane16_swap_b32 v43, v47
    v_pk_mul_f32 v[232:233], v[32:33], v[210:211] op_sel:[0,0] op_sel_hi:[1,0]
    v_pk_mul_f32 v[234:235], v[34:35], v[210:211] op_sel:[0,0] op_sel_hi:[1,0]
    v_pk_mul_f32 v[236:237], v[40:41], v[212:213] op_sel:[0,0] op_sel_hi:[1,0]
    v_pk_mul_f32 v[238:239], v[42:43], v[212:213] op_sel:[0,0] op_sel_hi:[1,0]
    v_pk_mul_f32 v[32:33], v[32:33], v[36:37]
    v_pk_mul_f32 v[34:35], v[34:35], v[38:39]
    v_pk_mul_f32 v[40:41], v[40:41], v[44:45]
    v_pk_mul_f32 v[42:43], v[42:43], v[46:47]
    s_waitcnt lgkmcnt(8)
    v_mfma_f32_16x16x32_bf16 v[48:51], v[136:139], v[172:175], v[48:51]
    v_exp_f32 v232, v232
    v_exp_f32 v233, v233
    v_mfma_f32_16x16x32_bf16 v[52:55], v[136:139], v[176:179], v[52:55]
    v_exp_f32 v234, v234
    v_exp_f32 v235, v235
    v_mfma_f32_16x16x32_bf16 v[56:59], v[136:139], v[180:183], v[56:59]
    v_exp_f32 v236, v236
    v_exp_f32 v237, v237
    v_mfma_f32_16x16x32_bf16 v[60:63], v[136:139], v[184:187], v[60:63]
    v_exp_f32 v238, v238
    v_exp_f32 v239, v239
    v_pk_fma_f32 v[232:233], v[232:233], v[210:211], v[210:211] op_sel:[0,1,1] op_sel_hi:[1,1,1]
    v_pk_fma_f32 v[234:235], v[234:235], v[210:211], v[210:211] op_sel:[0,1,1] op_sel_hi:[1,1,1]
    v_pk_fma_f32 v[236:237], v[236:237], v[212:213], v[212:213] op_sel:[0,1,1] op_sel_hi:[1,1,1]
    v_pk_fma_f32 v[238:239], v[238:239], v[212:213], v[212:213] op_sel:[0,1,1] op_sel_hi:[1,1,1]
    v_mfma_f32_16x16x16_bf16 v[48:51], v[192:193], v[202:203], v[48:51]
    v_rcp_f32 v232, v232
    v_rcp_f32 v233, v233
    v_mfma_f32_16x16x16_bf16 v[52:55], v[192:193], v[204:205], v[52:55]
    v_rcp_f32 v234, v234
    v_rcp_f32 v235, v235
    v_mfma_f32_16x16x16_bf16 v[56:59], v[192:193], v[206:207], v[56:59]
    v_rcp_f32 v236, v236
    v_rcp_f32 v237, v237
    v_mfma_f32_16x16x16_bf16 v[60:63], v[192:193], v[208:209], v[60:63]
    v_rcp_f32 v238, v238
    v_rcp_f32 v239, v239
    v_pk_mul_f32 v[32:33], v[32:33], v[232:233]
    v_pk_mul_f32 v[34:35], v[34:35], v[234:235]
    v_pk_mul_f32 v[40:41], v[40:41], v[236:237]
    v_pk_mul_f32 v[42:43], v[42:43], v[238:239]
    v_cvt_pk_bf16_f32 v12, v32, v33
    v_cvt_pk_bf16_f32 v13, v34, v35
    v_cvt_pk_bf16_f32 v14, v40, v41
    v_cvt_pk_bf16_f32 v15, v42, v43
    s_nop 0
    v_permlane32_swap_b32 v12, v14
    v_permlane32_swap_b32 v13, v15
    buffer_store_dwordx4 v[12:15], v218, s[8:11], s41 offen offset:256 sc1
    v_permlane16_swap_b32 v48, v52
    v_permlane16_swap_b32 v49, v53
    v_permlane16_swap_b32 v50, v54
    v_permlane16_swap_b32 v51, v55
    v_permlane16_swap_b32 v56, v60
    v_permlane16_swap_b32 v57, v61
    v_permlane16_swap_b32 v58, v62
    v_permlane16_swap_b32 v59, v63
    v_pk_mul_f32 v[232:233], v[48:49], v[210:211] op_sel:[0,0] op_sel_hi:[1,0]
    v_pk_mul_f32 v[234:235], v[50:51], v[210:211] op_sel:[0,0] op_sel_hi:[1,0]
    v_pk_mul_f32 v[236:237], v[56:57], v[212:213] op_sel:[0,0] op_sel_hi:[1,0]
    v_pk_mul_f32 v[238:239], v[58:59], v[212:213] op_sel:[0,0] op_sel_hi:[1,0]
    v_pk_mul_f32 v[48:49], v[48:49], v[52:53]
    v_pk_mul_f32 v[50:51], v[50:51], v[54:55]
    v_pk_mul_f32 v[56:57], v[56:57], v[60:61]
    v_pk_mul_f32 v[58:59], v[58:59], v[62:63]
    s_waitcnt lgkmcnt(6)
    v_mfma_f32_16x16x32_bf16 v[64:67], v[140:143], v[172:175], v[64:67]
    v_exp_f32 v232, v232
    v_exp_f32 v233, v233
    v_mfma_f32_16x16x32_bf16 v[68:71], v[140:143], v[176:179], v[68:71]
    v_exp_f32 v234, v234
    v_exp_f32 v235, v235
    v_mfma_f32_16x16x32_bf16 v[72:75], v[140:143], v[180:183], v[72:75]
    v_exp_f32 v236, v236
    v_exp_f32 v237, v237
    v_mfma_f32_16x16x32_bf16 v[76:79], v[140:143], v[184:187], v[76:79]
    v_exp_f32 v238, v238
    v_exp_f32 v239, v239
    v_pk_fma_f32 v[232:233], v[232:233], v[210:211], v[210:211] op_sel:[0,1,1] op_sel_hi:[1,1,1]
    v_pk_fma_f32 v[234:235], v[234:235], v[210:211], v[210:211] op_sel:[0,1,1] op_sel_hi:[1,1,1]
    v_pk_fma_f32 v[236:237], v[236:237], v[212:213], v[212:213] op_sel:[0,1,1] op_sel_hi:[1,1,1]
    v_pk_fma_f32 v[238:239], v[238:239], v[212:213], v[212:213] op_sel:[0,1,1] op_sel_hi:[1,1,1]
    v_mfma_f32_16x16x16_bf16 v[64:67], v[194:195], v[202:203], v[64:67]
    v_rcp_f32 v232, v232
    v_rcp_f32 v233, v233
    v_mfma_f32_16x16x16_bf16 v[68:71], v[194:195], v[204:205], v[68:71]
    v_rcp_f32 v234, v234
    v_rcp_f32 v235, v235
    v_mfma_f32_16x16x16_bf16 v[72:75], v[194:195], v[206:207], v[72:75]
    v_rcp_f32 v236, v236
    v_rcp_f32 v237, v237
    v_mfma_f32_16x16x16_bf16 v[76:79], v[194:195], v[208:209], v[76:79]
    v_rcp_f32 v238, v238
    v_rcp_f32 v239, v239
    v_pk_mul_f32 v[48:49], v[48:49], v[232:233]
    v_pk_mul_f32 v[50:51], v[50:51], v[234:235]
    v_pk_mul_f32 v[56:57], v[56:57], v[236:237]
    v_pk_mul_f32 v[58:59], v[58:59], v[238:239]
    v_cvt_pk_bf16_f32 v8, v48, v49
    v_cvt_pk_bf16_f32 v9, v50, v51
    v_cvt_pk_bf16_f32 v10, v56, v57
    v_cvt_pk_bf16_f32 v11, v58, v59
    s_nop 0
    v_permlane32_swap_b32 v8, v10
    v_permlane32_swap_b32 v9, v11
    buffer_store_dwordx4 v[8:11], v218, s[8:11], s41 offen offset:512 sc1
    v_permlane16_swap_b32 v64, v68
    v_permlane16_swap_b32 v65, v69
    v_permlane16_swap_b32 v66, v70
    v_permlane16_swap_b32 v67, v71
    v_permlane16_swap_b32 v72, v76
    v_permlane16_swap_b32 v73, v77
    v_permlane16_swap_b32 v74, v78
    v_permlane16_swap_b32 v75, v79
    v_pk_mul_f32 v[232:233], v[64:65], v[210:211] op_sel:[0,0] op_sel_hi:[1,0]
    v_pk_mul_f32 v[234:235], v[66:67], v[210:211] op_sel:[0,0] op_sel_hi:[1,0]
    v_pk_mul_f32 v[236:237], v[72:73], v[212:213] op_sel:[0,0] op_sel_hi:[1,0]
    v_pk_mul_f32 v[238:239], v[74:75], v[212:213] op_sel:[0,0] op_sel_hi:[1,0]
    v_pk_mul_f32 v[64:65], v[64:65], v[68:69]
    v_pk_mul_f32 v[66:67], v[66:67], v[70:71]
    v_pk_mul_f32 v[72:73], v[72:73], v[76:77]
    v_pk_mul_f32 v[74:75], v[74:75], v[78:79]
    s_waitcnt lgkmcnt(4)
    v_mfma_f32_16x16x32_bf16 v[80:83], v[144:147], v[172:175], v[80:83]
    v_exp_f32 v232, v232
    v_exp_f32 v233, v233
    v_mfma_f32_16x16x32_bf16 v[84:87], v[144:147], v[176:179], v[84:87]
    v_exp_f32 v234, v234
    v_exp_f32 v235, v235
    v_mfma_f32_16x16x32_bf16 v[88:91], v[144:147], v[180:183], v[88:91]
    v_exp_f32 v236, v236
    v_exp_f32 v237, v237
    v_mfma_f32_16x16x32_bf16 v[92:95], v[144:147], v[184:187], v[92:95]
    v_exp_f32 v238, v238
    v_exp_f32 v239, v239
    v_pk_fma_f32 v[232:233], v[232:233], v[210:211], v[210:211] op_sel:[0,1,1] op_sel_hi:[1,1,1]
    v_pk_fma_f32 v[234:235], v[234:235], v[210:211], v[210:211] op_sel:[0,1,1] op_sel_hi:[1,1,1]
    v_pk_fma_f32 v[236:237], v[236:237], v[212:213], v[212:213] op_sel:[0,1,1] op_sel_hi:[1,1,1]
    v_pk_fma_f32 v[238:239], v[238:239], v[212:213], v[212:213] op_sel:[0,1,1] op_sel_hi:[1,1,1]
    v_mfma_f32_16x16x16_bf16 v[80:83], v[196:197], v[202:203], v[80:83]
    v_rcp_f32 v232, v232
    v_rcp_f32 v233, v233
    v_mfma_f32_16x16x16_bf16 v[84:87], v[196:197], v[204:205], v[84:87]
    v_rcp_f32 v234, v234
    v_rcp_f32 v235, v235
    v_mfma_f32_16x16x16_bf16 v[88:91], v[196:197], v[206:207], v[88:91]
    v_rcp_f32 v236, v236
    v_rcp_f32 v237, v237
    v_mfma_f32_16x16x16_bf16 v[92:95], v[196:197], v[208:209], v[92:95]
    v_rcp_f32 v238, v238
    v_rcp_f32 v239, v239
    v_pk_mul_f32 v[64:65], v[64:65], v[232:233]
    v_pk_mul_f32 v[66:67], v[66:67], v[234:235]
    v_pk_mul_f32 v[72:73], v[72:73], v[236:237]
    v_pk_mul_f32 v[74:75], v[74:75], v[238:239]
    v_cvt_pk_bf16_f32 v12, v64, v65
    v_cvt_pk_bf16_f32 v13, v66, v67
    v_cvt_pk_bf16_f32 v14, v72, v73
    v_cvt_pk_bf16_f32 v15, v74, v75
    s_nop 0
    v_permlane32_swap_b32 v12, v14
    v_permlane32_swap_b32 v13, v15
    buffer_store_dwordx4 v[12:15], v218, s[8:11], s41 offen offset:768 sc1
    v_permlane16_swap_b32 v80, v84
    v_permlane16_swap_b32 v81, v85
    v_permlane16_swap_b32 v82, v86
    v_permlane16_swap_b32 v83, v87
    v_permlane16_swap_b32 v88, v92
    v_permlane16_swap_b32 v89, v93
    v_permlane16_swap_b32 v90, v94
    v_permlane16_swap_b32 v91, v95
    v_pk_mul_f32 v[232:233], v[80:81], v[210:211] op_sel:[0,0] op_sel_hi:[1,0]
    v_pk_mul_f32 v[234:235], v[82:83], v[210:211] op_sel:[0,0] op_sel_hi:[1,0]
    v_pk_mul_f32 v[236:237], v[88:89], v[212:213] op_sel:[0,0] op_sel_hi:[1,0]
    v_pk_mul_f32 v[238:239], v[90:91], v[212:213] op_sel:[0,0] op_sel_hi:[1,0]
    v_pk_mul_f32 v[80:81], v[80:81], v[84:85]
    v_pk_mul_f32 v[82:83], v[82:83], v[86:87]
    v_pk_mul_f32 v[88:89], v[88:89], v[92:93]
    v_pk_mul_f32 v[90:91], v[90:91], v[94:95]
    s_waitcnt lgkmcnt(2)
    v_mfma_f32_16x16x32_bf16 v[96:99], v[148:151], v[172:175], v[96:99]
    v_exp_f32 v232, v232
    v_exp_f32 v233, v233
    v_mfma_f32_16x16x32_bf16 v[100:103], v[148:151], v[176:179], v[100:103]
    v_exp_f32 v234, v234
    v_exp_f32 v235, v235
    v_mfma_f32_16x16x32_bf16 v[104:107], v[148:151], v[180:183], v[104:107]
    v_exp_f32 v236, v236
    v_exp_f32 v237, v237
    v_mfma_f32_16x16x32_bf16 v[108:111], v[148:151], v[184:187], v[108:111]
    v_exp_f32 v238, v238
    v_exp_f32 v239, v239
    v_pk_fma_f32 v[232:233], v[232:233], v[210:211], v[210:211] op_sel:[0,1,1] op_sel_hi:[1,1,1]
    v_pk_fma_f32 v[234:235], v[234:235], v[210:211], v[210:211] op_sel:[0,1,1] op_sel_hi:[1,1,1]
    v_pk_fma_f32 v[236:237], v[236:237], v[212:213], v[212:213] op_sel:[0,1,1] op_sel_hi:[1,1,1]
    v_pk_fma_f32 v[238:239], v[238:239], v[212:213], v[212:213] op_sel:[0,1,1] op_sel_hi:[1,1,1]
    v_mfma_f32_16x16x16_bf16 v[96:99], v[198:199], v[202:203], v[96:99]
    v_rcp_f32 v232, v232
    v_rcp_f32 v233, v233
    v_mfma_f32_16x16x16_bf16 v[100:103], v[198:199], v[204:205], v[100:103]
    v_rcp_f32 v234, v234
    v_rcp_f32 v235, v235
    v_mfma_f32_16x16x16_bf16 v[104:107], v[198:199], v[206:207], v[104:107]
    v_rcp_f32 v236, v236
    v_rcp_f32 v237, v237
    v_mfma_f32_16x16x16_bf16 v[108:111], v[198:199], v[208:209], v[108:111]
    v_rcp_f32 v238, v238
    v_rcp_f32 v239, v239
    v_pk_mul_f32 v[80:81], v[80:81], v[232:233]
    v_pk_mul_f32 v[82:83], v[82:83], v[234:235]
    v_pk_mul_f32 v[88:89], v[88:89], v[236:237]
    v_pk_mul_f32 v[90:91], v[90:91], v[238:239]
    v_cvt_pk_bf16_f32 v8, v80, v81
    v_cvt_pk_bf16_f32 v9, v82, v83
    v_cvt_pk_bf16_f32 v10, v88, v89
    v_cvt_pk_bf16_f32 v11, v90, v91
    s_nop 0
    v_permlane32_swap_b32 v8, v10
    v_permlane32_swap_b32 v9, v11
    buffer_store_dwordx4 v[8:11], v218, s[8:11], s42 offen offset:0 sc1
    v_permlane16_swap_b32 v96, v100
    v_permlane16_swap_b32 v97, v101
    v_permlane16_swap_b32 v98, v102
    v_permlane16_swap_b32 v99, v103
    v_permlane16_swap_b32 v104, v108
    v_permlane16_swap_b32 v105, v109
    v_permlane16_swap_b32 v106, v110
    v_permlane16_swap_b32 v107, v111
    v_pk_mul_f32 v[232:233], v[96:97], v[210:211] op_sel:[0,0] op_sel_hi:[1,0]
    v_pk_mul_f32 v[234:235], v[98:99], v[210:211] op_sel:[0,0] op_sel_hi:[1,0]
    v_pk_mul_f32 v[236:237], v[104:105], v[212:213] op_sel:[0,0] op_sel_hi:[1,0]
    v_pk_mul_f32 v[238:239], v[106:107], v[212:213] op_sel:[0,0] op_sel_hi:[1,0]
    v_pk_mul_f32 v[96:97], v[96:97], v[100:101]
    v_pk_mul_f32 v[98:99], v[98:99], v[102:103]
    v_pk_mul_f32 v[104:105], v[104:105], v[108:109]
    v_pk_mul_f32 v[106:107], v[106:107], v[110:111]
    s_waitcnt lgkmcnt(0)
    v_mfma_f32_16x16x32_bf16 v[112:115], v[152:155], v[172:175], v[112:115]
    v_exp_f32 v232, v232
    v_exp_f32 v233, v233
    v_mfma_f32_16x16x32_bf16 v[116:119], v[152:155], v[176:179], v[116:119]
    v_exp_f32 v234, v234
    v_exp_f32 v235, v235
    v_mfma_f32_16x16x32_bf16 v[120:123], v[152:155], v[180:183], v[120:123]
    v_exp_f32 v236, v236
    v_exp_f32 v237, v237
    v_mfma_f32_16x16x32_bf16 v[124:127], v[152:155], v[184:187], v[124:127]
    v_exp_f32 v238, v238
    v_exp_f32 v239, v239
    v_pk_fma_f32 v[232:233], v[232:233], v[210:211], v[210:211] op_sel:[0,1,1] op_sel_hi:[1,1,1]
    v_pk_fma_f32 v[234:235], v[234:235], v[210:211], v[210:211] op_sel:[0,1,1] op_sel_hi:[1,1,1]
    v_pk_fma_f32 v[236:237], v[236:237], v[212:213], v[212:213] op_sel:[0,1,1] op_sel_hi:[1,1,1]
    v_pk_fma_f32 v[238:239], v[238:239], v[212:213], v[212:213] op_sel:[0,1,1] op_sel_hi:[1,1,1]
    v_mfma_f32_16x16x16_bf16 v[112:115], v[200:201], v[202:203], v[112:115]
    v_rcp_f32 v232, v232
    v_rcp_f32 v233, v233
    v_mfma_f32_16x16x16_bf16 v[116:119], v[200:201], v[204:205], v[116:119]
    v_rcp_f32 v234, v234
    v_rcp_f32 v235, v235
    v_mfma_f32_16x16x16_bf16 v[120:123], v[200:201], v[206:207], v[120:123]
    v_rcp_f32 v236, v236
    v_rcp_f32 v237, v237
    v_mfma_f32_16x16x16_bf16 v[124:127], v[200:201], v[208:209], v[124:127]
    v_rcp_f32 v238, v238
    v_rcp_f32 v239, v239
    v_pk_mul_f32 v[96:97], v[96:97], v[232:233]
    v_pk_mul_f32 v[98:99], v[98:99], v[234:235]
    v_pk_mul_f32 v[104:105], v[104:105], v[236:237]
    v_pk_mul_f32 v[106:107], v[106:107], v[238:239]
    v_cvt_pk_bf16_f32 v12, v96, v97
    v_cvt_pk_bf16_f32 v13, v98, v99
    v_cvt_pk_bf16_f32 v14, v104, v105
    v_cvt_pk_bf16_f32 v15, v106, v107
    s_nop 0
    v_permlane32_swap_b32 v12, v14
    v_permlane32_swap_b32 v13, v15
    buffer_store_dwordx4 v[12:15], v218, s[8:11], s42 offen offset:256 sc1
    s_waitcnt vmcnt(2)
    s_mov_b64 exec, 1
    global_atomic_add v216, v254, s[58:59] sc1
    s_mov_b64 exec, -1
    v_permlane16_swap_b32 v112, v116
    v_permlane16_swap_b32 v113, v117
    v_permlane16_swap_b32 v114, v118
    v_permlane16_swap_b32 v115, v119
    v_permlane16_swap_b32 v120, v124
    v_permlane16_swap_b32 v121, v125
    v_permlane16_swap_b32 v122, v126
    v_permlane16_swap_b32 v123, v127
    v_pk_mul_f32 v[232:233], v[112:113], v[210:211] op_sel:[0,0] op_sel_hi:[1,0]
    v_pk_mul_f32 v[234:235], v[114:115], v[210:211] op_sel:[0,0] op_sel_hi:[1,0]
    v_pk_mul_f32 v[236:237], v[120:121], v[212:213] op_sel:[0,0] op_sel_hi:[1,0]
    v_pk_mul_f32 v[238:239], v[122:123], v[212:213] op_sel:[0,0] op_sel_hi:[1,0]
    v_pk_mul_f32 v[112:113], v[112:113], v[116:117]
    v_pk_mul_f32 v[114:115], v[114:115], v[118:119]
    v_pk_mul_f32 v[120:121], v[120:121], v[124:125]
    v_pk_mul_f32 v[122:123], v[122:123], v[126:127]
    v_exp_f32 v232, v232
    v_exp_f32 v233, v233
    v_exp_f32 v234, v234
    v_exp_f32 v235, v235
    v_exp_f32 v236, v236
    v_exp_f32 v237, v237
    v_exp_f32 v238, v238
    v_exp_f32 v239, v239
    v_pk_fma_f32 v[232:233], v[232:233], v[210:211], v[210:211] op_sel:[0,1,1] op_sel_hi:[1,1,1]
    v_pk_fma_f32 v[234:235], v[234:235], v[210:211], v[210:211] op_sel:[0,1,1] op_sel_hi:[1,1,1]
    v_pk_fma_f32 v[236:237], v[236:237], v[212:213], v[212:213] op_sel:[0,1,1] op_sel_hi:[1,1,1]
    v_pk_fma_f32 v[238:239], v[238:239], v[212:213], v[212:213] op_sel:[0,1,1] op_sel_hi:[1,1,1]
    v_rcp_f32 v232, v232
    v_rcp_f32 v233, v233
    v_rcp_f32 v234, v234
    v_rcp_f32 v235, v235
    v_rcp_f32 v236, v236
    v_rcp_f32 v237, v237
    v_rcp_f32 v238, v238
    v_rcp_f32 v239, v239
    v_pk_mul_f32 v[112:113], v[112:113], v[232:233]
    v_pk_mul_f32 v[114:115], v[114:115], v[234:235]
    v_pk_mul_f32 v[120:121], v[120:121], v[236:237]
    v_pk_mul_f32 v[122:123], v[122:123], v[238:239]
    v_cvt_pk_bf16_f32 v8, v112, v113
    v_cvt_pk_bf16_f32 v9, v114, v115
    v_cvt_pk_bf16_f32 v10, v120, v121
    v_cvt_pk_bf16_f32 v11, v122, v123
    s_nop 0
    v_permlane32_swap_b32 v8, v10
    v_permlane32_swap_b32 v9, v11
    buffer_store_dwordx4 v[8:11], v218, s[8:11], s42 offen offset:512 sc1
    s_lshl_b32 s24, s15, 2
    s_add_u32 s24, s24, s12
    s_mul_i32 s24, s24, 256
    s_add_u32 s24, s24, 25362432
    v_mov_b32 v248, s24
    v_mov_b32 v251, 0
    s_mov_b64 exec, 1
    global_atomic_add v249, v248, v251, s[58:59] sc0 sc1
    s_mov_b64 exec, -1
    s_add_u32 s24, s12, 0
    s_and_b32 s24, s24, 3
    s_lshl_b32 s25, s15, 2
    s_add_u32 s25, s24, s25
    s_mul_i32 s25, s25, 57472
    s_add_u32 s25, s25, 16777216
    v_add_u32 v244, s25, v229
    s_mul_i32 s24, s24, 12288
    v_add_u32 v240, s24, v229
    s_add_u32 s24, s12, 1
    s_and_b32 s24, s24, 3
    s_lshl_b32 s25, s15, 2
    s_add_u32 s25, s24, s25
    s_mul_i32 s25, s25, 57472
    s_add_u32 s25, s25, 16777216
    v_add_u32 v245, s25, v229
    s_mul_i32 s24, s24, 12288
    v_add_u32 v241, s24, v229
    s_add_u32 s24, s12, 2
    s_and_b32 s24, s24, 3
    s_lshl_b32 s25, s15, 2
    s_add_u32 s25, s24, s25
    s_mul_i32 s25, s25, 57472
    s_add_u32 s25, s25, 16777216
    v_add_u32 v246, s25, v229
    s_mul_i32 s24, s24, 12288
    v_add_u32 v242, s24, v229
    s_add_u32 s24, s12, 3
    s_and_b32 s24, s24, 3
    s_lshl_b32 s25, s15, 2
    s_add_u32 s25, s24, s25
    s_mul_i32 s25, s25, 57472
    s_add_u32 s25, s25, 16777216
    v_add_u32 v247, s25, v229
    s_mul_i32 s24, s24, 12288
    v_add_u32 v243, s24, v229
    s_waitcnt vmcnt(1)
    s_mov_b64 exec, 1
    global_atomic_add v217, v254, s[58:59] sc1
    s_mov_b64 exec, -1
    s_waitcnt vmcnt(1)
    v_readfirstlane_b32 s28, v249
    s_nop 0
    s_cmp_ge_u32 s28, 8
    s_cbranch_scc1 L_kf_p5ok
    s_lshl_b32 s24, s15, 2
    s_add_u32 s24, s24, s12
    s_mul_i32 s24, s24, 256
    s_add_u32 s24, s24, 25362432
    v_mov_b32 v248, s24
    v_mov_b32 v251, 0
    s_mov_b32 s30, 0
    s_mov_b64 exec, 1
L_kf_p5:
    global_atomic_add v249, v248, v251, s[58:59] sc0 sc1
    s_add_u32 s30, s30, 1
    s_waitcnt vmcnt(0)
    v_readfirstlane_b32 s28, v249
    s_nop 0
    s_cmp_ge_u32 s28, 8
    s_cbranch_scc1 L_kf_p5d
    s_cmp_lt_u32 s30, 0x100000
    s_cbranch_scc1 L_kf_p5
L_kf_p5d:
    s_mov_b64 exec, -1
L_kf_p5ok:
    v_add_u32 v248, 65536, v248
    buffer_load_dwordx4 v[112:115], v244, s[8:11], s44 offen offset:0 sc1
    buffer_load_dwordx4 v[116:119], v245, s[8:11], s44 offen offset:0 sc1
    buffer_load_dwordx4 v[120:123], v246, s[8:11], s44 offen offset:0 sc1
    buffer_load_dwordx4 v[124:127], v247, s[8:11], s44 offen offset:0 sc1
    buffer_load_dwordx4 v[192:195], v244, s[8:11], s44 offen offset:1024 sc1
    buffer_load_dwordx4 v[196:199], v245, s[8:11], s44 offen offset:1024 sc1
    buffer_load_dwordx4 v[200:203], v246, s[8:11], s44 offen offset:1024 sc1
    buffer_load_dwordx4 v[204:207], v247, s[8:11], s44 offen offset:1024 sc1
    s_mov_b64 exec, 1
    global_atomic_add v249, v248, v251, s[58:59] sc0 sc1
    s_mov_b64 exec, -1
    s_lshl_b32 s24, s12, 2
    v_add_u32 v7, s24, v252
L_ka_w11:
    ds_read_b32 v255, v7 offset:160
    s_waitcnt lgkmcnt(0)
    v_readfirstlane_b32 s63, v255
    s_nop 0
    s_cmp_lt_u32 s63, 1
    s_cbranch_scc1 L_ka_w11
    s_mul_i32 s24, s12, 2048
    s_add_u32 s24, s24, 154368
    v_add_u32 v7, s24, v229
    ds_read_b128 v[16:19], v7 offset:0
    ds_read_b128 v[20:23], v7 offset:1024
    s_mul_i32 s24, s12, 7168
    s_add_u32 s24, s24, 57408
    v_add_u32 v7, s24, v229
    ds_read_b128 v[24:27], v7 offset:0
    ds_read_b128 v[28:31], v7 offset:1024
    ds_read_b128 v[32:35], v7 offset:2048
    ds_read_b128 v[36:39], v7 offset:3072
    ds_read_b128 v[40:43], v7 offset:4096
    ds_read_b128 v[44:47], v7 offset:5120
    ds_read_b128 v[48:51], v7 offset:6144
    s_mul_i32 s24, s12, 4096
    s_add_u32 s24, s24, 119296
    v_add_u32 v7, s24, v229
    ds_read_b128 v[52:55], v7 offset:0
    ds_read_b128 v[56:59], v7 offset:1024
    ds_read_b128 v[60:63], v7 offset:2048
    ds_read_b128 v[64:67], v7 offset:3072
    s_mul_i32 s24, s12, 7168
    s_add_u32 s24, s24, 0
    v_add_u32 v7, s24, v229
    ds_read_b128 v[68:71], v7 offset:0
    ds_read_b128 v[72:75], v7 offset:1024
    ds_read_b128 v[76:79], v7 offset:2048
    ds_read_b128 v[80:83], v7 offset:3072
    ds_read_b128 v[84:87], v7 offset:4096
    ds_read_b128 v[88:91], v7 offset:5120
    ds_read_b128 v[92:95], v7 offset:6144
    s_mul_i32 s24, s12, 4096
    s_add_u32 s24, s24, 86528
    v_add_u32 v7, s24, v229
    ds_read_b128 v[96:99], v7 offset:0
    ds_read_b128 v[100:103], v7 offset:1024
    ds_read_b128 v[104:107], v7 offset:2048
    ds_read_b128 v[108:111], v7 offset:3072
    s_mov_b64 exec, 1
    ds_add_u32 v252, v254 offset:144
    s_mov_b64 exec, -1
    s_waitcnt lgkmcnt(0)
    s_waitcnt vmcnt(8)
    v_mfma_f32_16x16x32_bf16 v[128:131], v[16:19], v[112:115], 0
    buffer_load_dwordx4 v[208:211], v244, s[8:11], s44 offen offset:2048 sc1
    v_mfma_f32_16x16x32_bf16 v[132:135], v[20:23], v[112:115], 0
    v_mfma_f32_16x16x32_bf16 v[136:139], v[24:27], v[112:115], 0
    v_mfma_f32_16x16x32_bf16 v[140:143], v[28:31], v[112:115], 0
    s_waitcnt vmcnt(8)
    v_mfma_f32_16x16x32_bf16 v[144:147], v[16:19], v[116:119], 0
    buffer_load_dwordx4 v[212:215], v245, s[8:11], s44 offen offset:2048 sc1
    v_mfma_f32_16x16x32_bf16 v[148:151], v[20:23], v[116:119], 0
    v_mfma_f32_16x16x32_bf16 v[152:155], v[24:27], v[116:119], 0
    v_mfma_f32_16x16x32_bf16 v[156:159], v[28:31], v[116:119], 0
    s_waitcnt vmcnt(8)
    v_mfma_f32_16x16x32_bf16 v[160:163], v[16:19], v[120:123], 0
    buffer_load_dwordx4 v[216:219], v246, s[8:11], s44 offen offset:2048 sc1
    v_mfma_f32_16x16x32_bf16 v[164:167], v[20:23], v[120:123], 0
    v_mfma_f32_16x16x32_bf16 v[168:171], v[24:27], v[120:123], 0
    v_mfma_f32_16x16x32_bf16 v[172:175], v[28:31], v[120:123], 0
    s_waitcnt vmcnt(8)
    v_mfma_f32_16x16x32_bf16 v[176:179], v[16:19], v[124:127], 0
    buffer_load_dwordx4 v[220:223], v247, s[8:11], s44 offen offset:2048 sc1
    v_mfma_f32_16x16x32_bf16 v[180:183], v[20:23], v[124:127], 0
    v_mfma_f32_16x16x32_bf16 v[184:187], v[24:27], v[124:127], 0
    v_mfma_f32_16x16x32_bf16 v[188:191], v[28:31], v[124:127], 0
    s_waitcnt vmcnt(8)
    v_mfma_f32_16x16x32_bf16 v[128:131], v[32:35], v[192:195], v[128:131]
    v_mfma_f32_16x16x32_bf16 v[132:135], v[36:39], v[192:195], v[132:135]
    v_mfma_f32_16x16x32_bf16 v[136:139], v[40:43], v[192:195], v[136:139]
    v_mfma_f32_16x16x32_bf16 v[140:143], v[44:47], v[192:195], v[140:143]
    s_waitcnt vmcnt(7)
    v_mfma_f32_16x16x32_bf16 v[144:147], v[32:35], v[196:199], v[144:147]
    v_mfma_f32_16x16x32_bf16 v[148:151], v[36:39], v[196:199], v[148:151]
    v_mfma_f32_16x16x32_bf16 v[152:155], v[40:43], v[196:199], v[152:155]
    v_mfma_f32_16x16x32_bf16 v[156:159], v[44:47], v[196:199], v[156:159]
    s_waitcnt vmcnt(6)
    v_mfma_f32_16x16x32_bf16 v[160:163], v[32:35], v[200:203], v[160:163]
    v_mfma_f32_16x16x32_bf16 v[164:167], v[36:39], v[200:203], v[164:167]
    v_mfma_f32_16x16x32_bf16 v[168:171], v[40:43], v[200:203], v[168:171]
    v_mfma_f32_16x16x32_bf16 v[172:175], v[44:47], v[200:203], v[172:175]
    s_waitcnt vmcnt(5)
    v_mfma_f32_16x16x32_bf16 v[176:179], v[32:35], v[204:207], v[176:179]
    v_mfma_f32_16x16x32_bf16 v[180:183], v[36:39], v[204:207], v[180:183]
    v_mfma_f32_16x16x32_bf16 v[184:187], v[40:43], v[204:207], v[184:187]
    v_mfma_f32_16x16x32_bf16 v[188:191], v[44:47], v[204:207], v[188:191]
    s_waitcnt vmcnt(4)
    v_readfirstlane_b32 s28, v249
    s_nop 0
    s_cmp_ge_u32 s28, 8
    s_cbranch_scc1 L_kf_p6ok
    s_lshl_b32 s24, s15, 2
    s_add_u32 s24, s24, s12
    s_mul_i32 s24, s24, 256
    s_add_u32 s24, s24, 25427968
    v_mov_b32 v248, s24
    v_mov_b32 v251, 0
    s_mov_b32 s30, 0
    s_mov_b64 exec, 1
L_kf_p6:
    global_atomic_add v249, v248, v251, s[58:59] sc0 sc1
    s_add_u32 s30, s30, 1
    s_waitcnt vmcnt(0)
    v_readfirstlane_b32 s28, v249
    s_nop 0
    s_cmp_ge_u32 s28, 8
    s_cbranch_scc1 L_kf_p6d
    s_cmp_lt_u32 s30, 0x100000
    s_cbranch_scc1 L_kf_p6
L_kf_p6d:
    s_mov_b64 exec, -1
L_kf_p6ok:
    s_waitcnt vmcnt(3)
    v_mfma_f32_16x16x32_bf16 v[128:131], v[48:51], v[208:211], v[128:131]
    buffer_load_dwordx4 v[224:227], v244, s[8:11], s29 offen offset:0 sc1
    v_mfma_f32_16x16x32_bf16 v[132:135], v[52:55], v[208:211], v[132:135]
    v_mfma_f32_16x16x32_bf16 v[136:139], v[56:59], v[208:211], v[136:139]
    buffer_load_dwordx4 v[232:235], v245, s[8:11], s29 offen offset:0 sc1
    v_mfma_f32_16x16x32_bf16 v[140:143], v[60:63], v[208:211], v[140:143]
    s_waitcnt vmcnt(4)
    v_mfma_f32_16x16x32_bf16 v[144:147], v[48:51], v[212:215], v[144:147]
    buffer_load_dwordx4 v[236:239], v246, s[8:11], s29 offen offset:0 sc1
    v_mfma_f32_16x16x32_bf16 v[148:151], v[52:55], v[212:215], v[148:151]
    v_mfma_f32_16x16x32_bf16 v[152:155], v[56:59], v[212:215], v[152:155]
    buffer_load_dwordx4 v[112:115], v247, s[8:11], s29 offen offset:0 sc1
    v_mfma_f32_16x16x32_bf16 v[156:159], v[60:63], v[212:215], v[156:159]
    s_waitcnt vmcnt(5)
    v_mfma_f32_16x16x32_bf16 v[160:163], v[48:51], v[216:219], v[160:163]
    buffer_load_dwordx4 v[116:119], v244, s[8:11], s29 offen offset:1024 sc1
    v_mfma_f32_16x16x32_bf16 v[164:167], v[52:55], v[216:219], v[164:167]
    v_mfma_f32_16x16x32_bf16 v[168:171], v[56:59], v[216:219], v[168:171]
    buffer_load_dwordx4 v[120:123], v245, s[8:11], s29 offen offset:1024 sc1
    v_mfma_f32_16x16x32_bf16 v[172:175], v[60:63], v[216:219], v[172:175]
    s_waitcnt vmcnt(6)
    v_mfma_f32_16x16x32_bf16 v[176:179], v[48:51], v[220:223], v[176:179]
    buffer_load_dwordx4 v[124:127], v246, s[8:11], s29 offen offset:1024 sc1
    v_mfma_f32_16x16x32_bf16 v[180:183], v[52:55], v[220:223], v[180:183]
    v_mfma_f32_16x16x32_bf16 v[184:187], v[56:59], v[220:223], v[184:187]
    buffer_load_dwordx4 v[16:19], v247, s[8:11], s29 offen offset:1024 sc1
    v_mfma_f32_16x16x32_bf16 v[188:191], v[60:63], v[220:223], v[188:191]
    s_waitcnt vmcnt(7)
    v_mfma_f32_16x16x32_bf16 v[128:131], v[64:67], v[224:227], v[128:131]
    buffer_load_dwordx4 v[20:23], v244, s[8:11], s29 offen offset:2048 sc1
    v_mfma_f32_16x16x32_bf16 v[132:135], v[68:71], v[224:227], v[132:135]
    v_mfma_f32_16x16x32_bf16 v[136:139], v[72:75], v[224:227], v[136:139]
    v_mfma_f32_16x16x32_bf16 v[140:143], v[76:79], v[224:227], v[140:143]
    s_waitcnt vmcnt(7)
    v_mfma_f32_16x16x32_bf16 v[144:147], v[64:67], v[232:235], v[144:147]
    buffer_load_dwordx4 v[24:27], v245, s[8:11], s29 offen offset:2048 sc1
    v_mfma_f32_16x16x32_bf16 v[148:151], v[68:71], v[232:235], v[148:151]
    v_mfma_f32_16x16x32_bf16 v[152:155], v[72:75], v[232:235], v[152:155]
    v_mfma_f32_16x16x32_bf16 v[156:159], v[76:79], v[232:235], v[156:159]
    s_waitcnt vmcnt(7)
    v_mfma_f32_16x16x32_bf16 v[160:163], v[64:67], v[236:239], v[160:163]
    buffer_load_dwordx4 v[28:31], v246, s[8:11], s29 offen offset:2048 sc1
    v_mfma_f32_16x16x32_bf16 v[164:167], v[68:71], v[236:239], v[164:167]
    v_mfma_f32_16x16x32_bf16 v[168:171], v[72:75], v[236:239], v[168:171]
    v_mfma_f32_16x16x32_bf16 v[172:175], v[76:79], v[236:239], v[172:175]
    s_waitcnt vmcnt(7)
    v_mfma_f32_16x16x32_bf16 v[176:179], v[64:67], v[112:115], v[176:179]
    buffer_load_dwordx4 v[192:195], v247, s[8:11], s29 offen offset:2048 sc1
    v_mfma_f32_16x16x32_bf16 v[180:183], v[68:71], v[112:115], v[180:183]
    v_mfma_f32_16x16x32_bf16 v[184:187], v[72:75], v[112:115], v[184:187]
    v_mfma_f32_16x16x32_bf16 v[188:191], v[76:79], v[112:115], v[188:191]
    s_waitcnt vmcnt(7)
    v_mfma_f32_16x16x32_bf16 v[128:131], v[80:83], v[116:119], v[128:131]
    v_mfma_f32_16x16x32_bf16 v[132:135], v[84:87], v[116:119], v[132:135]
    v_mfma_f32_16x16x32_bf16 v[136:139], v[88:91], v[116:119], v[136:139]
    v_mfma_f32_16x16x32_bf16 v[140:143], v[92:95], v[116:119], v[140:143]
    s_waitcnt vmcnt(6)
    v_mfma_f32_16x16x32_bf16 v[144:147], v[80:83], v[120:123], v[144:147]
    v_mfma_f32_16x16x32_bf16 v[148:151], v[84:87], v[120:123], v[148:151]
    v_mfma_f32_16x16x32_bf16 v[152:155], v[88:91], v[120:123], v[152:155]
    v_mfma_f32_16x16x32_bf16 v[156:159], v[92:95], v[120:123], v[156:159]
    s_waitcnt vmcnt(5)
    v_mfma_f32_16x16x32_bf16 v[160:163], v[80:83], v[124:127], v[160:163]
    v_mfma_f32_16x16x32_bf16 v[164:167], v[84:87], v[124:127], v[164:167]
    v_mfma_f32_16x16x32_bf16 v[168:171], v[88:91], v[124:127], v[168:171]
    v_mfma_f32_16x16x32_bf16 v[172:175], v[92:95], v[124:127], v[172:175]
    s_waitcnt vmcnt(4)
    v_mfma_f32_16x16x32_bf16 v[176:179], v[80:83], v[16:19], v[176:179]
    v_mfma_f32_16x16x32_bf16 v[180:183], v[84:87], v[16:19], v[180:183]
    v_mfma_f32_16x16x32_bf16 v[184:187], v[88:91], v[16:19], v[184:187]
    v_mfma_f32_16x16x32_bf16 v[188:191], v[92:95], v[16:19], v[188:191]
L_ka_w12:
    ds_read_b32 v255, v252 offset:144
    s_waitcnt lgkmcnt(0)
    v_readfirstlane_b32 s63, v255
    s_nop 0
    s_cmp_lt_u32 s63, 4
    s_cbranch_scc1 L_ka_w12
    s_waitcnt vmcnt(2)
    v_mfma_f32_16x16x32_bf16 v[144:147], v[96:99], v[24:27], v[144:147]
    v_mfma_f32_16x16x32_bf16 v[148:151], v[100:103], v[24:27], v[148:151]
    v_mfma_f32_16x16x32_bf16 v[152:155], v[104:107], v[24:27], v[152:155]
    v_mfma_f32_16x16x32_bf16 v[156:159], v[108:111], v[24:27], v[156:159]
    s_waitcnt vmcnt(1)
    v_mfma_f32_16x16x32_bf16 v[160:163], v[96:99], v[28:31], v[160:163]
    v_mfma_f32_16x16x32_bf16 v[164:167], v[100:103], v[28:31], v[164:167]
    v_mfma_f32_16x16x32_bf16 v[168:171], v[104:107], v[28:31], v[168:171]
    v_mfma_f32_16x16x32_bf16 v[172:175], v[108:111], v[28:31], v[172:175]
    s_waitcnt vmcnt(0)
    v_mfma_f32_16x16x32_bf16 v[176:179], v[96:99], v[192:195], v[176:179]
    ds_write_b128 v241, v[144:147] offset:0
    v_mfma_f32_16x16x32_bf16 v[180:183], v[100:103], v[192:195], v[180:183]
    ds_write_b128 v241, v[148:151] offset:1024
    v_mfma_f32_16x16x32_bf16 v[184:187], v[104:107], v[192:195], v[184:187]
    ds_write_b128 v241, v[152:155] offset:2048
    v_mfma_f32_16x16x32_bf16 v[188:191], v[108:111], v[192:195], v[188:191]
    ds_write_b128 v241, v[156:159] offset:3072
    v_mfma_f32_16x16x32_bf16 v[128:131], v[96:99], v[20:23], v[128:131]
    ds_write_b128 v242, v[160:163] offset:4096
    v_mfma_f32_16x16x32_bf16 v[132:135], v[100:103], v[20:23], v[132:135]
    ds_write_b128 v242, v[164:167] offset:5120
    v_mfma_f32_16x16x32_bf16 v[136:139], v[104:107], v[20:23], v[136:139]
    ds_write_b128 v242, v[168:171] offset:6144
    v_mfma_f32_16x16x32_bf16 v[140:143], v[108:111], v[20:23], v[140:143]
    ds_write_b128 v242, v[172:175] offset:7168
    ds_write_b128 v243, v[176:179] offset:8192
    ds_write_b128 v243, v[180:183] offset:9216
    ds_write_b128 v243, v[184:187] offset:10240
    ds_write_b128 v243, v[188:191] offset:11264
    s_mov_b64 exec, 1
    ds_add_u32 v252, v254 offset:136
    s_mov_b64 exec, -1
L_ka_w13:
    ds_read_b32 v255, v252 offset:136
    s_waitcnt lgkmcnt(0)
    v_readfirstlane_b32 s63, v255
    s_nop 0
    s_cmp_lt_u32 s63, 4
    s_cbranch_scc1 L_ka_w13
    ds_read_b128 v[16:19], v240 offset:0
    ds_read_b128 v[20:23], v240 offset:1024
    ds_read_b128 v[24:27], v240 offset:2048
    ds_read_b128 v[28:31], v240 offset:3072
    ds_read_b128 v[32:35], v240 offset:4096
    ds_read_b128 v[36:39], v240 offset:5120
    ds_read_b128 v[40:43], v240 offset:6144
    ds_read_b128 v[44:47], v240 offset:7168
    ds_read_b128 v[48:51], v240 offset:8192
    ds_read_b128 v[52:55], v240 offset:9216
    ds_read_b128 v[56:59], v240 offset:10240
    ds_read_b128 v[60:63], v240 offset:11264
    s_lshl_b32 s24, s12, 12
    v_add_u32 v2, s24, v229
    s_waitcnt lgkmcnt(11)
    v_add_f32 v128, v128, v16
    v_add_f32 v129, v129, v17
    v_add_f32 v130, v130, v18
    v_add_f32 v131, v131, v19
    s_waitcnt lgkmcnt(10)
    v_add_f32 v132, v132, v20
    v_add_f32 v133, v133, v21
    v_add_f32 v134, v134, v22
    v_add_f32 v135, v135, v23
    s_waitcnt lgkmcnt(9)
    v_add_f32 v136, v136, v24
    v_add_f32 v137, v137, v25
    v_add_f32 v138, v138, v26
    v_add_f32 v139, v139, v27
    s_waitcnt lgkmcnt(8)
    v_add_f32 v140, v140, v28
    v_add_f32 v141, v141, v29
    v_add_f32 v142, v142, v30
    v_add_f32 v143, v143, v31
    s_waitcnt lgkmcnt(7)
    v_add_f32 v128, v128, v32
    v_add_f32 v129, v129, v33
    v_add_f32 v130, v130, v34
    v_add_f32 v131, v131, v35
    s_waitcnt lgkmcnt(6)
    v_add_f32 v132, v132, v36
    v_add_f32 v133, v133, v37
    v_add_f32 v134, v134, v38
    v_add_f32 v135, v135, v39
    s_waitcnt lgkmcnt(5)
    v_add_f32 v136, v136, v40
    v_add_f32 v137, v137, v41
    v_add_f32 v138, v138, v42
    v_add_f32 v139, v139, v43
    s_waitcnt lgkmcnt(4)
    v_add_f32 v140, v140, v44
    v_add_f32 v141, v141, v45
    v_add_f32 v142, v142, v46
    v_add_f32 v143, v143, v47
    s_waitcnt lgkmcnt(3)
    v_add_f32 v128, v128, v48
    v_add_f32 v129, v129, v49
    v_add_f32 v130, v130, v50
    v_add_f32 v131, v131, v51
    s_waitcnt lgkmcnt(2)
    v_add_f32 v132, v132, v52
    v_add_f32 v133, v133, v53
    v_add_f32 v134, v134, v54
    v_add_f32 v135, v135, v55
    s_waitcnt lgkmcnt(1)
    v_add_f32 v136, v136, v56
    v_add_f32 v137, v137, v57
    v_add_f32 v138, v138, v58
    v_add_f32 v139, v139, v59
    s_waitcnt lgkmcnt(0)
    v_add_f32 v140, v140, v60
    v_add_f32 v141, v141, v61
    v_add_f32 v142, v142, v62
    v_add_f32 v143, v143, v63
    ds_write_b128 v2, v[128:131] offset:49152
    ds_write_b128 v2, v[132:135] offset:50176
    ds_write_b128 v2, v[136:139] offset:51200
    ds_write_b128 v2, v[140:143] offset:52224
    s_waitcnt lgkmcnt(0)
    s_barrier
    s_branch L_kf_fin
L_kf_loader:
    s_mul_i32 s29, s12, 6144
    s_add_u32 s29, s29, 32768
    s_lshl_b32 s28, s29, 2
    s_add_u32 s52, s43, s28
    s_lshl_b32 s44, s12, 13
    s_lshl_b32 s28, s12, 15
    s_add_u32 s43, s43, s28
    s_mul_i32 s17, s14, 224
    s_mul_i32 s19, s40, 14352
    s_mul_i32 s28, s39, 7168
    s_add_u32 s19, s19, s28
    s_cmp_eq_u32 s40, 0
    s_cselect_b32 s32, s20, s22
    s_cselect_b32 s33, s21, s23
    s_mov_b32 s34, 1835008
    s_mov_b32 s35, 0x20000
    s_mul_i32 s28, s39, 448
    v_add_u32 v2, s28, v1
    v_mul_u32_u24 v3, 4682, v2
    v_lshrrev_b32 v3, 16, v3
    v_mul_u32_u24 v3, 3360, v3
    v_lshl_add_u32 v230, v2, 4, v3
    v_add_u32 v2, 64, v2
    v_mul_u32_u24 v3, 4682, v2
    v_lshrrev_b32 v3, 16, v3
    v_mul_u32_u24 v3, 3360, v3
    v_lshl_add_u32 v231, v2, 4, v3
    v_subrev_u32 v231, 1024, v231
    v_add_u32 v2, 64, v2
    v_mul_u32_u24 v3, 4682, v2
    v_lshrrev_b32 v3, 16, v3
    v_mul_u32_u24 v3, 3360, v3
    v_lshl_add_u32 v232, v2, 4, v3
    v_subrev_u32 v232, 2048, v232
    v_add_u32 v2, 64, v2
    v_mul_u32_u24 v3, 4682, v2
    v_lshrrev_b32 v3, 16, v3
    v_mul_u32_u24 v3, 3360, v3
    v_lshl_add_u32 v233, v2, 4, v3
    v_subrev_u32 v233, 3072, v233
    v_add_u32 v2, 64, v2
    v_mul_u32_u24 v3, 4682, v2
    v_lshrrev_b32 v3, 16, v3
    v_mul_u32_u24 v3, 3360, v3
    v_lshl_add_u32 v234, v2, 4, v3
    v_add_u32 v2, 64, v2
    v_mul_u32_u24 v3, 4682, v2
    v_lshrrev_b32 v3, 16, v3
    v_mul_u32_u24 v3, 3360, v3
    v_lshl_add_u32 v235, v2, 4, v3
    v_subrev_u32 v235, 1024, v235
    v_add_u32 v2, 64, v2
    v_mul_u32_u24 v3, 4682, v2
    v_lshrrev_b32 v3, 16, v3
    v_mul_u32_u24 v3, 3360, v3
    v_lshl_add_u32 v236, v2, 4, v3
    v_subrev_u32 v236, 2048, v236
L_ka_w14:
    ds_read_b32 v255, v252 offset:52
    s_waitcnt lgkmcnt(0)
    v_readfirstlane_b32 s63, v255
    s_nop 0
    s_cmp_lt_u32 s63, 1
    s_cbranch_scc1 L_ka_w14
    s_add_u32 s17, s17, 458752
    s_add_u32 m0, s19, 57408
    s_nop 0
    buffer_load_dwordx4 v230, s[32:35], s17 offen offset:0  lds
    buffer_load_dwordx4 v231, s[32:35], s17 offen offset:1024  lds
    buffer_load_dwordx4 v232, s[32:35], s17 offen offset:2048  lds
    buffer_load_dwordx4 v233, s[32:35], s17 offen offset:3072  lds
    s_add_u32 m0, s19, 61504
    s_nop 0
    buffer_load_dwordx4 v234, s[32:35], s17 offen offset:0  lds
    buffer_load_dwordx4 v235, s[32:35], s17 offen offset:1024  lds
    buffer_load_dwordx4 v236, s[32:35], s17 offen offset:2048  lds
    s_add_u32 s17, s17, 229376
    v_add_u32 v56, s19, v229
    s_mov_b32 s5, 229376
    s_add_u32 s24, s14, 1
    s_bitcmp1_b32 s24, 1
    s_cbranch_scc0 L_kf_noside
    s_mul_i32 s17, s14, 143360
    s_mul_i32 s24, s12, 7168
    s_add_u32 s17, s17, s24
    s_add_u32 s17, s17, 7340032
    s_mov_b32 s5, 28672
    s_mov_b32 s32, s58
    s_mov_b32 s33, s59
    s_mov_b32 s34, 27262976
    v_mov_b32 v230, v229
    v_mov_b32 v231, v229
    v_mov_b32 v232, v229
    v_mov_b32 v233, v229
    v_add_u32 v234, 4096, v229
    v_add_u32 v235, 4096, v229
    v_add_u32 v236, 4096, v229
L_kf_noside:
    s_lshl_b32 s24, s12, 11
    s_add_u32 s51, s24, 142848
    s_lshl_b32 s25, s15, 1
    s_add_u32 s25, s25, s40
    s_mul_i32 s25, s25, 33024
    s_lshl_b32 s28, s16, 12
    s_add_u32 s25, s25, s28
    s_lshl_b32 s28, s39, 11
    s_add_u32 s25, s25, s28
    s_add_u32 s53, s25, 4718592
    s_mul_i32 s24, s12, 1792
    s_add_u32 s49, s24, 135680
    s_mul_i32 s48, s14, 448
    s_mul_i32 s24, s12, 28672
    s_add_u32 s48, s48, s24
    s_add_u32 s48, s48, 6848512
    v_cmp_lt_u32 vcc, 27, v1
    v_add_u32 v55, 6720, v229
    s_nop 0
    v_cndmask_b32 v55, v229, v55, vcc
    v_lshrrev_b32 v2, 4, v1
    v_lshrrev_b32 v3, 2, v1
    v_lshlrev_b32 v3, 6, v3
    v_and_b32 v4, 3, v1
    v_lshl_add_u32 v3, v4, 3, v3
    v_and_b32 v5, 1, v2
    v_xor_b32 v5, s39, v5
    v_lshl_add_u32 v3, v5, 5, v3
    s_lshl_b32 s24, s40, 12
    s_add_u32 s24, s24, 142848
    v_add_u32 v7, s24, v3
    v_cmp_eq_u32 s[46:47], 1, v4
    v_cmp_eq_u32 s[54:55], 2, v4
    v_cmp_eq_u32 s[60:61], 3, v4
    v_bfe_u32 v4, v1, 2, 2
    v_cmp_eq_u32 s[64:65], v2, v4
    v_mov_b32 v12, 0x3f803f80
    v_mov_b32 v13, 0x3f803f80
    v_mov_b32 v14, 0x3f803f80
    v_mov_b32 v15, 0x3f803f80
    s_lshl_b32 s24, s13, 14
    s_add_u32 s41, s24, 6979584
    s_lshr_b32 s24, s15, 1
    s_lshl_b32 s24, s24, 14
    s_lshl_b32 s25, s16, 10
    s_add_u32 s24, s24, s25
    s_and_b32 s25, s15, 1
    s_lshl_b32 s25, s25, 9
    s_add_u32 s24, s24, s25
    s_lshl_b32 s25, s12, 7
    s_add_u32 s24, s24, s25
    s_add_u32 s42, s24, 6979584
    v_and_b32 v9, 15, v1
    v_lshlrev_b32 v9, 3, v9
    v_and_b32 v10, 15, v1
    s_lshl_b32 s24, s12, 8
    v_lshl_add_u32 v10, v10, 4, s24
    v_lshrrev_b32 v11, 4, v1
    v_lshl_add_u32 v11, v11, 11, v10
    v_lshrrev_b32 v8, 5, v1
    v_lshl_add_u32 v10, v8, 3, v10
    v_add_u32 v10, 152064, v10
    s_add_u32 s18, s18, 8192
    s_setprio 2
    s_mov_b32 s31, 0
    s_cmp_lg_u32 s26, 4
    s_cbranch_scc1 L_kf_q0
    s_bfe_u32 s28, s2, 0x30003
    s_mul_i32 s28, s28, 4096
    s_add_u32 s28, s28, 25296896
    v_mul_u32_u24 v4, 256, v1
    v_add_u32 v4, s28, v4
    v_mov_b32 v6, 0
    s_mov_b32 s30, 0
L_kf_q1:
    s_mov_b32 exec_lo, 0xffff
    s_mov_b32 exec_hi, 0
    global_atomic_add v5, v4, v6, s[58:59] sc0 sc1
    s_add_u32 s30, s30, 1
    s_waitcnt vmcnt(0)
    v_cmp_ne_u32 vcc, 16, v5
    s_mov_b64 exec, -1
    s_cmp_lt_u32 s30, 0x100000
    s_cselect_b32 s31, vcc_lo, 0
    s_and_b32 s28, s31, 0x303
    s_cbranch_scc1 L_kf_q1
L_kf_q5:
    s_mov_b64 exec, 1
    ds_add_u32 v252, v254 offset:56
    s_mov_b64 exec, -1
    s_cmp_eq_u32 s31, 0
    s_cbranch_scc1 L_kf_q0
    s_mov_b32 exec_lo, 0xffff
    s_mov_b32 exec_hi, 0
    global_atomic_add v5, v4, v6, s[58:59] sc0 sc1
    s_add_u32 s30, s30, 1
    s_waitcnt vmcnt(0)
    v_cmp_ne_u32 vcc, 16, v5
    s_mov_b64 exec, -1
    s_cmp_lt_u32 s30, 0x100000
    s_cselect_b32 s31, vcc_lo, 0
L_kf_q0:
    s_barrier
    s_cmp_lg_u32 s26, 4
    s_cbranch_scc1 L_kf_q3
L_kf_q2:
    s_cmp_eq_u32 s31, 0
    s_cbranch_scc1 L_kf_q4
    s_mov_b32 exec_lo, 0xffff
    s_mov_b32 exec_hi, 0
    global_atomic_add v5, v4, v6, s[58:59] sc0 sc1
    s_add_u32 s30, s30, 1
    s_waitcnt vmcnt(0)
    v_cmp_ne_u32 vcc, 16, v5
    s_mov_b64 exec, -1
    s_cmp_lt_u32 s30, 0x100000
    s_cselect_b32 s31, vcc_lo, 0
    s_branch L_kf_q2
L_kf_q4:
    s_mov_b64 exec, 1
    ds_add_u32 v252, v254 offset:60
    s_mov_b64 exec, -1
L_kf_q3:
L_ka_w15:
    ds_read_b32 v255, v252 offset:60
    s_waitcnt lgkmcnt(0)
    v_readfirstlane_b32 s63, v255
    s_nop 0
    s_cmp_lt_u32 s63, 1
    s_cbranch_scc1 L_ka_w15
    s_mov_b32 m0, s51
    s_nop 0
    buffer_load_dwordx4 v229, s[8:11], s53 offen offset:0 sc1 lds
    buffer_load_dwordx4 v229, s[8:11], s53 offen offset:1024 sc1 lds
    s_add_u32 m0, s4, 32768
    s_nop 0
    buffer_load_dwordx4 v229, s[8:11], s18 offen offset:0 sc1 lds
    buffer_load_dwordx4 v229, s[8:11], s18 offen offset:1024 sc1 lds
    buffer_load_dwordx4 v229, s[8:11], s18 offen offset:2048 sc1 lds
    buffer_load_dwordx4 v229, s[8:11], s18 offen offset:3072 sc1 lds
    s_add_u32 s18, s18, 4096
    s_barrier
    s_add_u32 m0, s4, 0
    s_nop 0
    buffer_load_dwordx4 v229, s[8:11], s18 offen offset:0 sc1 lds
    buffer_load_dwordx4 v229, s[8:11], s18 offen offset:1024 sc1 lds
    buffer_load_dwordx4 v229, s[8:11], s18 offen offset:2048 sc1 lds
    buffer_load_dwordx4 v229, s[8:11], s18 offen offset:3072 sc1 lds
    s_add_u32 s18, s18, 4096
    s_add_u32 m0, s19, 0
    s_nop 0
    buffer_load_dwordx4 v230, s[32:35], s17 offen offset:0 sc1 lds
    buffer_load_dwordx4 v231, s[32:35], s17 offen offset:1024 sc1 lds
    buffer_load_dwordx4 v232, s[32:35], s17 offen offset:2048 sc1 lds
    buffer_load_dwordx4 v233, s[32:35], s17 offen offset:3072 sc1 lds
    s_add_u32 m0, s19, 4096
    s_nop 0
    buffer_load_dwordx4 v234, s[32:35], s17 offen offset:0 sc1 lds
    buffer_load_dwordx4 v235, s[32:35], s17 offen offset:1024 sc1 lds
    buffer_load_dwordx4 v236, s[32:35], s17 offen offset:2048 sc1 lds
    s_add_u32 s17, s17, s5
    s_waitcnt vmcnt(11)
    s_barrier
    s_add_u32 m0, s4, 16384
    s_nop 0
    buffer_load_dwordx4 v229, s[8:11], s18 offen offset:0 sc1 lds
    buffer_load_dwordx4 v229, s[8:11], s18 offen offset:1024 sc1 lds
    buffer_load_dwordx4 v229, s[8:11], s18 offen offset:2048 sc1 lds
    buffer_load_dwordx4 v229, s[8:11], s18 offen offset:3072 sc1 lds
    s_add_u32 s18, s18, 4096
    s_add_u32 m0, s19, 28704
    s_nop 0
    buffer_load_dwordx4 v230, s[32:35], s17 offen offset:0 sc1 lds
    buffer_load_dwordx4 v231, s[32:35], s17 offen offset:1024 sc1 lds
    buffer_load_dwordx4 v232, s[32:35], s17 offen offset:2048 sc1 lds
    buffer_load_dwordx4 v233, s[32:35], s17 offen offset:3072 sc1 lds
    s_add_u32 m0, s19, 32800
    s_nop 0
    buffer_load_dwordx4 v234, s[32:35], s17 offen offset:0 sc1 lds
    buffer_load_dwordx4 v235, s[32:35], s17 offen offset:1024 sc1 lds
    buffer_load_dwordx4 v236, s[32:35], s17 offen offset:2048 sc1 lds
    s_add_u32 s17, s17, s5
    ds_read_b64_tr_b16 v[16:17], v7 offset:0
    ds_read_b64_tr_b16 v[18:19], v7 offset:1024
    ds_read_b64_tr_b16 v[20:21], v7 offset:2048
    ds_read_b64_tr_b16 v[22:23], v7 offset:3072
    s_waitcnt lgkmcnt(0)
    v_mfma_f32_16x16x32_bf16 v[28:31], v[16:19], v[16:19], 0
    v_mfma_f32_16x16x32_bf16 v[24:27], v[12:15], v[16:19], 0
    v_mfma_f32_16x16x32_bf16 v[28:31], v[20:23], v[20:23], v[28:31]
    v_mfma_f32_16x16x32_bf16 v[24:27], v[12:15], v[20:23], v[24:27]
    s_nop 6
    v_cndmask_b32 v28, v28, v29, s[46:47]
    v_cndmask_b32 v28, v28, v30, s[54:55]
    v_cndmask_b32 v25, v28, v31, s[60:61]
    s_mov_b64 exec, s[64:65]
    buffer_store_dwordx2 v[24:25], v9, s[8:11], s42 offen sc1
    s_mov_b64 exec, -1
    buffer_load_dwordx4 v[96:99], v229, s[8:11], s43 offen offset:0 sc1
    buffer_load_dwordx4 v[100:103], v229, s[8:11], s43 offen offset:1024 sc1
    s_waitcnt vmcnt(14)
    s_barrier
    s_add_u32 m0, s4, 32768
    s_nop 0
    buffer_load_dwordx4 v229, s[8:11], s18 offen offset:0 sc1 lds
    buffer_load_dwordx4 v229, s[8:11], s18 offen offset:1024 sc1 lds
    buffer_load_dwordx4 v229, s[8:11], s18 offen offset:2048 sc1 lds
    buffer_load_dwordx4 v229, s[8:11], s18 offen offset:3072 sc1 lds
    s_add_u32 s18, s18, 4096
    s_add_u32 m0, s19, 57408
    s_nop 0
    buffer_load_dwordx4 v230, s[32:35], s17 offen offset:0 sc1 lds
    buffer_load_dwordx4 v231, s[32:35], s17 offen offset:1024 sc1 lds
    buffer_load_dwordx4 v232, s[32:35], s17 offen offset:2048 sc1 lds
    buffer_load_dwordx4 v233, s[32:35], s17 offen offset:3072 sc1 lds
    s_add_u32 m0, s19, 61504
    s_nop 0
    buffer_load_dwordx4 v234, s[32:35], s17 offen offset:0 sc1 lds
    buffer_load_dwordx4 v235, s[32:35], s17 offen offset:1024 sc1 lds
    buffer_load_dwordx4 v236, s[32:35], s17 offen offset:2048 sc1 lds
    s_add_u32 s17, s17, s5
    buffer_load_dwordx4 v[104:107], v229, s[8:11], s43 offen offset:2048 sc1
    buffer_load_dwordx4 v[108:111], v229, s[8:11], s43 offen offset:3072 sc1
    s_add_u32 s43, s43, 4096
    s_waitcnt vmcnt(16)
    s_barrier
    s_add_u32 m0, s4, 0
    s_nop 0
    buffer_load_dwordx4 v229, s[8:11], s18 offen offset:0 sc1 lds
    buffer_load_dwordx4 v229, s[8:11], s18 offen offset:1024 sc1 lds
    buffer_load_dwordx4 v229, s[8:11], s18 offen offset:2048 sc1 lds
    buffer_load_dwordx4 v229, s[8:11], s18 offen offset:3072 sc1 lds
    s_add_u32 s18, s18, 4096
    s_add_u32 m0, s19, 0
    s_nop 0
    buffer_load_dwordx4 v230, s[32:35], s17 offen offset:0 sc1 lds
    buffer_load_dwordx4 v231, s[32:35], s17 offen offset:1024 sc1 lds
    buffer_load_dwordx4 v232, s[32:35], s17 offen offset:2048 sc1 lds
    buffer_load_dwordx4 v233, s[32:35], s17 offen offset:3072 sc1 lds
    s_add_u32 m0, s19, 4096
    s_nop 0
    buffer_load_dwordx4 v234, s[32:35], s17 offen offset:0 sc1 lds
    buffer_load_dwordx4 v235, s[32:35], s17 offen offset:1024 sc1 lds
    buffer_load_dwordx4 v236, s[32:35], s17 offen offset:2048 sc1 lds
    s_add_u32 s17, s17, s5
    buffer_load_dwordx4 v[40:43], v11, s[8:11], s41 offen offset:0 sc1
    buffer_load_dwordx4 v[44:47], v11, s[8:11], s41 offen offset:1024 sc1
    buffer_load_dwordx4 v[112:115], v229, s[8:11], s43 offen offset:0 sc1
    buffer_load_dwordx4 v[116:119], v229, s[8:11], s43 offen offset:1024 sc1
    s_waitcnt vmcnt(17)
    s_barrier
    s_add_u32 m0, s4, 16384
    s_nop 0
    buffer_load_dwordx4 v229, s[8:11], s18 offen offset:0 sc1 lds
    buffer_load_dwordx4 v229, s[8:11], s18 offen offset:1024 sc1 lds
    buffer_load_dwordx4 v229, s[8:11], s18 offen offset:2048 sc1 lds
    buffer_load_dwordx4 v229, s[8:11], s18 offen offset:3072 sc1 lds
    s_add_u32 s18, s18, 4096
    s_add_u32 m0, s19, 28704
    s_nop 0
    buffer_load_dwordx4 v230, s[32:35], s17 offen offset:0 sc1 lds
    buffer_load_dwordx4 v231, s[32:35], s17 offen offset:1024 sc1 lds
    buffer_load_dwordx4 v232, s[32:35], s17 offen offset:2048 sc1 lds
    buffer_load_dwordx4 v233, s[32:35], s17 offen offset:3072 sc1 lds
    s_add_u32 m0, s19, 32800
    s_nop 0
    buffer_load_dwordx4 v234, s[32:35], s17 offen offset:0 sc1 lds
    buffer_load_dwordx4 v235, s[32:35], s17 offen offset:1024 sc1 lds
    buffer_load_dwordx4 v236, s[32:35], s17 offen offset:2048 sc1 lds
    s_add_u32 s17, s17, s5
    s_waitcnt vmcnt(13)
    v_add_f32 v40, v40, v44
    v_add_f32 v41, v41, v45
    v_add_f32 v42, v42, v46
    v_add_f32 v43, v43, v47
    s_nop 0
    v_permlane32_swap_b32 v40, v42
    v_permlane32_swap_b32 v41, v43
    v_add_f32 v40, v40, v42
    v_add_f32 v41, v41, v43
    v_mov_b32 v42, v40
    v_mov_b32 v43, v41
    s_nop 0
    v_permlane16_swap_b32 v40, v42
    v_permlane16_swap_b32 v41, v43
    v_add_f32 v40, v40, v42
    v_add_f32 v41, v41, v43
    v_cmp_u_f32 vcc, v41, v41
    s_mov_b32 s30, 0
    s_nop 3
    s_cbranch_vccnz L_kf_retry
L_kf_statok:
    v_mul_f32 v40, 0x3b000000, v40
    v_mul_f32 v41, 0x3b000000, v41
    v_fma_f32 v41, -v40, v40, v41
    v_cvt_pk_bf16_f32 v42, -v40, -v40
    v_max_f32 v41, 0, v41
    v_mov_b32 v43, v42
    v_cvt_pk_bf16_f32 v41, v41, v41
    ds_write_b64 v10, v[42:43]
    v_and_b32 v41, s36, v41
    v_add_f32 v41, 0x3727c5ac, v41
    v_cvt_pk_bf16_f32 v41, v41, v41
    v_and_b32 v41, s36, v41
    v_sqrt_f32 v41, v41
    s_nop 0
    v_cvt_pk_bf16_f32 v41, v41, v41
    v_and_b32 v41, s36, v41
    v_rcp_f32 v40, v41
    v_mul_f32 v41, v41, v41
    v_mul_f32 v40, 0xbfb8aa3b, v40
    ds_write_b64 v10, v[40:41] offset:1024
    buffer_load_dwordx4 v[120:123], v229, s[8:11], s43 offen offset:2048 sc1
    buffer_load_dwordx4 v[124:127], v229, s[8:11], s43 offen offset:3072 sc1
    s_add_u32 s43, s43, 4096
    buffer_load_dwordx4 v[128:131], v229, s[8:11], s43 offen offset:0 sc1
    buffer_load_dwordx4 v[132:135], v229, s[8:11], s43 offen offset:1024 sc1
    s_barrier
    s_mov_b32 m0, s49
    s_mov_b32 exec_hi, 0x00ffffff
    buffer_load_dwordx4 v55, s[8:11], s48 offen offset:0 sc1 lds
    s_add_u32 s48, s48, 13440
    buffer_load_dwordx4 v55, s[8:11], s48 offen offset:896 sc1 lds
    s_add_u32 s48, s48, 13440
    s_mov_b64 exec, -1
    buffer_load_dwordx4 v[136:139], v229, s[8:11], s43 offen offset:2048 sc1
    buffer_load_dwordx4 v[140:143], v229, s[8:11], s43 offen offset:3072 sc1
    s_add_u32 s43, s43, 4096
    buffer_load_dwordx4 v[144:147], v229, s[8:11], s43 offen offset:0 sc1
    buffer_load_dwordx4 v[148:151], v229, s[8:11], s43 offen offset:1024 sc1
    buffer_load_dwordx4 v[152:155], v229, s[8:11], s43 offen offset:2048 sc1
    buffer_load_dwordx4 v[156:159], v229, s[8:11], s43 offen offset:3072 sc1
    s_add_u32 s43, s43, 4096
    buffer_load_dwordx4 v[160:163], v229, s[8:11], s43 offen offset:0 sc1
    buffer_load_dwordx4 v[164:167], v229, s[8:11], s43 offen offset:1024 sc1
    buffer_load_dwordx4 v[168:171], v229, s[8:11], s43 offen offset:2048 sc1
    buffer_load_dwordx4 v[172:175], v229, s[8:11], s43 offen offset:3072 sc1
    s_add_u32 s43, s43, 4096
    buffer_load_dwordx4 v[176:179], v229, s[8:11], s52 offen offset:0 sc1
    buffer_load_dwordx4 v[180:183], v229, s[8:11], s52 offen offset:1024 sc1
    s_waitcnt vmcnt(18)
    s_waitcnt vmcnt(12)
    s_waitcnt lgkmcnt(0)
    s_barrier
    s_setprio 0
    s_cmp_ge_u32 s2, 16
    s_cbranch_scc1 L_kf_cl
    s_cmp_lg_u32 s26, 5
    s_cbranch_scc1 L_kf_cl
    v_mov_b32 v58, 0
    v_mov_b32 v59, 0
    s_mul_i32 s28, s2, 256
    s_add_u32 s28, s28, 25231360
    v_mul_u32_u24 v57, 4096, v1
    v_add_u32 v57, s28, v57
    s_mov_b32 exec_lo, 0xff
    s_mov_b32 exec_hi, 0
    global_store_dwordx2 v57, v[58:59], s[58:59] sc1
    s_mov_b64 exec, -1
L_kf_cl:
    buffer_load_dwordx4 v[184:187], v229, s[8:11], s52 offen offset:2048 sc1
    s_waitcnt vmcnt(11)
    buffer_load_dwordx4 v[188:191], v229, s[8:11], s52 offen offset:3072 sc1
    s_add_u32 s52, s52, 4096
    s_waitcnt vmcnt(11)
    buffer_load_dwordx4 v[192:195], v229, s[8:11], s52 offen offset:0 sc1
    s_waitcnt vmcnt(11)
    buffer_load_dwordx4 v[196:199], v229, s[8:11], s52 offen offset:1024 sc1
    s_waitcnt vmcnt(11)
    buffer_load_dwordx4 v[200:203], v229, s[8:11], s52 offen offset:2048 sc1
    s_waitcnt vmcnt(11)
    buffer_load_dwordx4 v[204:207], v229, s[8:11], s52 offen offset:3072 sc1
    s_add_u32 s52, s52, 4096
    s_waitcnt vmcnt(11)
    buffer_load_dwordx4 v[208:211], v229, s[8:11], s52 offen offset:0 sc1
    s_waitcnt vmcnt(11)
    buffer_load_dwordx4 v[212:215], v229, s[8:11], s52 offen offset:1024 sc1
    s_waitcnt vmcnt(11)
    buffer_load_dwordx4 v[216:219], v229, s[8:11], s52 offen offset:2048 sc1
    s_waitcnt vmcnt(11)
    buffer_load_dwordx4 v[220:223], v229, s[8:11], s52 offen offset:3072 sc1
    s_add_u32 s52, s52, 4096
    s_waitcnt vmcnt(11)
    s_mul_i32 s24, s12, 2048
    s_add_u32 m0, s24, 154368
    s_nop 0
    buffer_load_dwordx4 v229, s[8:11], s43 offen sc1 lds
    s_add_u32 s43, s43, 1024
    s_waitcnt vmcnt(11)
    s_mul_i32 s24, s12, 2048
    s_add_u32 m0, s24, 155392
    s_nop 0
    buffer_load_dwordx4 v229, s[8:11], s43 offen sc1 lds
    s_add_u32 s43, s43, 1024
    s_waitcnt vmcnt(11)
    s_mul_i32 s24, s12, 7168
    s_add_u32 m0, s24, 57408
    s_nop 0
    buffer_load_dwordx4 v229, s[8:11], s43 offen sc1 lds
    s_add_u32 s43, s43, 1024
    s_waitcnt vmcnt(11)
    s_mul_i32 s24, s12, 7168
    s_add_u32 m0, s24, 58432
    s_nop 0
    buffer_load_dwordx4 v229, s[8:11], s43 offen sc1 lds
    s_add_u32 s43, s43, 1024
    s_waitcnt vmcnt(11)
    s_mul_i32 s24, s12, 7168
    s_add_u32 m0, s24, 59456
    s_nop 0
    buffer_load_dwordx4 v229, s[8:11], s43 offen sc1 lds
    s_add_u32 s43, s43, 1024
    s_waitcnt vmcnt(11)
    s_mul_i32 s24, s12, 7168
    s_add_u32 m0, s24, 60480
    s_nop 0
    buffer_load_dwordx4 v229, s[8:11], s43 offen sc1 lds
    s_add_u32 s43, s43, 1024
    s_waitcnt vmcnt(11)
    s_mul_i32 s24, s12, 7168
    s_add_u32 m0, s24, 61504
    s_nop 0
    buffer_load_dwordx4 v229, s[8:11], s43 offen sc1 lds
    s_add_u32 s43, s43, 1024
    s_waitcnt vmcnt(11)
    s_mul_i32 s24, s12, 7168
    s_add_u32 m0, s24, 62528
    s_nop 0
    buffer_load_dwordx4 v229, s[8:11], s43 offen sc1 lds
    s_add_u32 s43, s43, 1024
    s_waitcnt vmcnt(11)
    s_mul_i32 s24, s12, 7168
    s_add_u32 m0, s24, 63552
    s_nop 0
    buffer_load_dwordx4 v229, s[8:11], s43 offen sc1 lds
    s_add_u32 s43, s43, 1024
    s_waitcnt vmcnt(11)
    s_mul_i32 s24, s12, 4096
    s_add_u32 m0, s24, 119296
    s_nop 0
    buffer_load_dwordx4 v229, s[8:11], s43 offen sc1 lds
    s_add_u32 s43, s43, 1024
    s_waitcnt vmcnt(11)
    s_mul_i32 s24, s12, 4096
    s_add_u32 m0, s24, 120320
    s_nop 0
    buffer_load_dwordx4 v229, s[8:11], s43 offen sc1 lds
    s_add_u32 s43, s43, 1024
    s_waitcnt vmcnt(11)
    s_mul_i32 s24, s12, 4096
    s_add_u32 m0, s24, 121344
    s_nop 0
    buffer_load_dwordx4 v229, s[8:11], s43 offen sc1 lds
    s_add_u32 s43, s43, 1024
    s_waitcnt vmcnt(11)
    s_mul_i32 s24, s12, 4096
    s_add_u32 m0, s24, 122368
    s_nop 0
    buffer_load_dwordx4 v229, s[8:11], s52 offen sc1 lds
    s_add_u32 s52, s52, 1024
    s_waitcnt vmcnt(11)
    s_mul_i32 s24, s12, 7168
    s_add_u32 m0, s24, 0
    s_nop 0
    buffer_load_dwordx4 v229, s[8:11], s52 offen sc1 lds
    s_add_u32 s52, s52, 1024
    s_waitcnt vmcnt(11)
    s_mul_i32 s24, s12, 7168
    s_add_u32 m0, s24, 1024
    s_nop 0
    buffer_load_dwordx4 v229, s[8:11], s52 offen sc1 lds
    s_add_u32 s52, s52, 1024
    s_waitcnt vmcnt(11)
    s_mul_i32 s24, s12, 7168
    s_add_u32 m0, s24, 2048
    s_nop 0
    buffer_load_dwordx4 v229, s[8:11], s52 offen sc1 lds
    s_add_u32 s52, s52, 1024
    s_waitcnt vmcnt(11)
    s_mul_i32 s24, s12, 7168
    s_add_u32 m0, s24, 3072
    s_nop 0
    buffer_load_dwordx4 v229, s[8:11], s52 offen sc1 lds
    s_add_u32 s52, s52, 1024
    s_waitcnt vmcnt(11)
    s_mul_i32 s24, s12, 7168
    s_add_u32 m0, s24, 4096
    s_nop 0
    buffer_load_dwordx4 v229, s[8:11], s52 offen sc1 lds
    s_add_u32 s52, s52, 1024
    s_waitcnt vmcnt(11)
    s_mul_i32 s24, s12, 7168
    s_add_u32 m0, s24, 5120
    s_nop 0
    buffer_load_dwordx4 v229, s[8:11], s52 offen sc1 lds
    s_add_u32 s52, s52, 1024
    s_waitcnt vmcnt(11)
    s_mul_i32 s24, s12, 7168
    s_add_u32 m0, s24, 6144
    s_nop 0
    buffer_load_dwordx4 v229, s[8:11], s52 offen sc1 lds
    s_add_u32 s52, s52, 1024
    s_waitcnt vmcnt(11)
    s_mul_i32 s24, s12, 4096
    s_add_u32 m0, s24, 86528
    s_nop 0
    buffer_load_dwordx4 v229, s[8:11], s52 offen sc1 lds
    s_add_u32 s52, s52, 1024
    s_waitcnt vmcnt(11)
    s_mul_i32 s24, s12, 4096
    s_add_u32 m0, s24, 87552
    s_nop 0
    buffer_load_dwordx4 v229, s[8:11], s52 offen sc1 lds
    s_add_u32 s52, s52, 1024
    s_waitcnt vmcnt(11)
    s_mul_i32 s24, s12, 4096
    s_add_u32 m0, s24, 88576
    s_nop 0
    buffer_load_dwordx4 v229, s[8:11], s52 offen sc1 lds
    s_add_u32 s52, s52, 1024
    s_waitcnt vmcnt(11)
    s_mul_i32 s24, s12, 4096
    s_add_u32 m0, s24, 89600
    s_nop 0
    buffer_load_dwordx4 v229, s[8:11], s52 offen sc1 lds
    s_add_u32 s52, s52, 1024
    s_waitcnt vmcnt(11)
    s_setprio 0
    s_add_u32 s24, s12, 0
    s_and_b32 s24, s24, 3
    s_lshl_b32 s25, s15, 2
    s_add_u32 s25, s24, s25
    s_mul_i32 s25, s25, 57472
    s_add_u32 s25, s25, 16777216
    v_add_u32 v244, s25, v229
    s_mul_i32 s24, s24, 12288
    v_add_u32 v240, s24, v229
    s_add_u32 s24, s12, 1
    s_and_b32 s24, s24, 3
    s_lshl_b32 s25, s15, 2
    s_add_u32 s25, s24, s25
    s_mul_i32 s25, s25, 57472
    s_add_u32 s25, s25, 16777216
    v_add_u32 v245, s25, v229
    s_mul_i32 s24, s24, 12288
    v_add_u32 v241, s24, v229
    s_add_u32 s24, s12, 2
    s_and_b32 s24, s24, 3
    s_lshl_b32 s25, s15, 2
    s_add_u32 s25, s24, s25
    s_mul_i32 s25, s25, 57472
    s_add_u32 s25, s25, 16777216
    v_add_u32 v246, s25, v229
    s_mul_i32 s24, s24, 12288
    v_add_u32 v242, s24, v229
    s_add_u32 s24, s12, 3
    s_and_b32 s24, s24, 3
    s_lshl_b32 s25, s15, 2
    s_add_u32 s25, s24, s25
    s_mul_i32 s25, s25, 57472
    s_add_u32 s25, s25, 16777216
    v_add_u32 v247, s25, v229
    s_mul_i32 s24, s24, 12288
    v_add_u32 v243, s24, v229
    v_add_u32 v240, 65536, v240
    v_add_u32 v241, 65536, v241
    v_add_u32 v242, 65536, v242
    v_add_u32 v243, 65536, v243
    v_bfe_u32 v2, v1, 4, 1
    v_lshrrev_b32 v3, 5, v1
    v_lshl_add_u32 v2, v2, 1, v3
    v_bfe_u32 v3, v1, 2, 2
    v_lshl_add_u32 v3, v2, 4, v3
    v_lshlrev_b32 v3, 6, v3
    v_and_b32 v4, 3, v1
    v_lshl_add_u32 v3, v4, 3, v3
    s_lshl_b32 s24, s40, 12
    s_lshl_b32 s25, s39, 5
    s_add_u32 s24, s24, s25
    s_add_u32 s24, s24, 142848
    v_add_u32 v3, s24, v3
    v_xor_b32 v4, 32, v3
    ds_read_b64_tr_b16 v[8:9], v3 offset:0
    ds_read_b64_tr_b16 v[10:11], v4 offset:256
    ds_read_b64_tr_b16 v[12:13], v3 offset:512
    ds_read_b64_tr_b16 v[14:15], v4 offset:768
    s_lshl_b32 s24, s15, 16
    s_lshl_b32 s25, s12, 14
    s_add_u32 s24, s24, s25
    s_lshl_b32 s25, s16, 7
    s_add_u32 s24, s24, s25
    v_and_b32 v5, 15, v1
    v_lshlrev_b32 v5, 10, v5
    v_lshrrev_b32 v2, 4, v1
    v_lshl_add_u32 v5, v2, 4, v5
    v_add_u32 v5, s24, v5
    s_lshl_b32 s24, s12, 12
    v_add_u32 v6, s24, v229
    s_lshl_b32 s24, s12, 2
    v_add_u32 v7, s24, v252
    s_waitcnt lgkmcnt(0)
    s_waitcnt vmcnt(0)
    s_mov_b64 exec, 1
    ds_add_u32 v7, v254 offset:160
    s_mov_b64 exec, -1
    s_lshl_b32 s24, s15, 2
    s_add_u32 s24, s24, s12
    s_mul_i32 s24, s24, 256
    s_add_u32 s24, s24, 25362432
    v_mov_b32 v248, s24
    v_mov_b32 v251, 0
    s_mov_b32 s30, 0
    s_mov_b64 exec, 1
L_kf_p4:
    global_atomic_add v249, v248, v251, s[58:59] sc0 sc1
    s_add_u32 s30, s30, 1
    s_waitcnt vmcnt(0)
    v_readfirstlane_b32 s28, v249
    s_nop 0
    s_cmp_ge_u32 s28, 8
    s_cbranch_scc1 L_kf_p4d
    s_cmp_lt_u32 s30, 0x100000
    s_cbranch_scc1 L_kf_p4
L_kf_p4d:
    s_mov_b64 exec, -1
    v_add_u32 v248, 65536, v248
    buffer_load_dwordx4 v[80:83], v244, s[8:11], s44 offen offset:0 sc1
    buffer_load_dwordx4 v[84:87], v245, s[8:11], s44 offen offset:0 sc1
    buffer_load_dwordx4 v[88:91], v246, s[8:11], s44 offen offset:0 sc1
    buffer_load_dwordx4 v[92:95], v247, s[8:11], s44 offen offset:0 sc1
    buffer_load_dwordx4 v[224:227], v244, s[8:11], s44 offen offset:1024 sc1
    buffer_load_dwordx4 v[232:235], v245, s[8:11], s44 offen offset:1024 sc1
    buffer_load_dwordx4 v[236:239], v246, s[8:11], s44 offen offset:1024 sc1
    s_waitcnt vmcnt(6)
    v_mfma_f32_16x16x32_bf16 v[16:19], v[96:99], v[80:83], 0
    v_mfma_f32_16x16x32_bf16 v[20:23], v[100:103], v[80:83], 0
    v_mfma_f32_16x16x32_bf16 v[24:27], v[104:107], v[80:83], 0
    v_mfma_f32_16x16x32_bf16 v[28:31], v[108:111], v[80:83], 0
    s_waitcnt vmcnt(5)
    v_mfma_f32_16x16x32_bf16 v[32:35], v[96:99], v[84:87], 0
    buffer_load_dwordx4 v[80:83], v247, s[8:11], s44 offen offset:1024 sc1
    v_mfma_f32_16x16x32_bf16 v[36:39], v[100:103], v[84:87], 0
    v_mfma_f32_16x16x32_bf16 v[40:43], v[104:107], v[84:87], 0
    v_mfma_f32_16x16x32_bf16 v[44:47], v[108:111], v[84:87], 0
    s_waitcnt vmcnt(5)
    v_mfma_f32_16x16x32_bf16 v[48:51], v[96:99], v[88:91], 0
    buffer_load_dwordx4 v[84:87], v244, s[8:11], s44 offen offset:2048 sc1
    v_mfma_f32_16x16x32_bf16 v[52:55], v[100:103], v[88:91], 0
    v_mfma_f32_16x16x32_bf16 v[56:59], v[104:107], v[88:91], 0
    v_mfma_f32_16x16x32_bf16 v[60:63], v[108:111], v[88:91], 0
    s_waitcnt vmcnt(5)
    v_mfma_f32_16x16x32_bf16 v[64:67], v[96:99], v[92:95], 0
    buffer_load_dwordx4 v[88:91], v245, s[8:11], s44 offen offset:2048 sc1
    v_mfma_f32_16x16x32_bf16 v[68:71], v[100:103], v[92:95], 0
    v_mfma_f32_16x16x32_bf16 v[72:75], v[104:107], v[92:95], 0
    v_mfma_f32_16x16x32_bf16 v[76:79], v[108:111], v[92:95], 0
    s_waitcnt vmcnt(5)
    v_mfma_f32_16x16x32_bf16 v[16:19], v[112:115], v[224:227], v[16:19]
    buffer_load_dwordx4 v[92:95], v246, s[8:11], s44 offen offset:2048 sc1
    v_mfma_f32_16x16x32_bf16 v[20:23], v[116:119], v[224:227], v[20:23]
    v_mfma_f32_16x16x32_bf16 v[24:27], v[120:123], v[224:227], v[24:27]
    buffer_load_dwordx4 v[96:99], v247, s[8:11], s44 offen offset:2048 sc1
    s_mov_b64 exec, 1
    global_atomic_add v249, v248, v251, s[58:59] sc0 sc1
    s_mov_b64 exec, -1
    v_mfma_f32_16x16x32_bf16 v[28:31], v[124:127], v[224:227], v[28:31]
    s_waitcnt vmcnt(7)
    v_mfma_f32_16x16x32_bf16 v[32:35], v[112:115], v[232:235], v[32:35]
    buffer_load_dwordx4 v[100:103], v244, s[8:11], s44 offen offset:3072 sc1
    v_mfma_f32_16x16x32_bf16 v[36:39], v[116:119], v[232:235], v[36:39]
    v_mfma_f32_16x16x32_bf16 v[40:43], v[120:123], v[232:235], v[40:43]
    buffer_load_dwordx4 v[104:107], v245, s[8:11], s44 offen offset:3072 sc1
    v_mfma_f32_16x16x32_bf16 v[44:47], v[124:127], v[232:235], v[44:47]
    s_waitcnt vmcnt(8)
    v_mfma_f32_16x16x32_bf16 v[48:51], v[112:115], v[236:239], v[48:51]
    buffer_load_dwordx4 v[108:111], v246, s[8:11], s44 offen offset:3072 sc1
    v_mfma_f32_16x16x32_bf16 v[52:55], v[116:119], v[236:239], v[52:55]
    v_mfma_f32_16x16x32_bf16 v[56:59], v[120:123], v[236:239], v[56:59]
    v_mfma_f32_16x16x32_bf16 v[60:63], v[124:127], v[236:239], v[60:63]
    s_waitcnt vmcnt(8)
    v_mfma_f32_16x16x32_bf16 v[64:67], v[112:115], v[80:83], v[64:67]
    buffer_load_dwordx4 v[224:227], v247, s[8:11], s44 offen offset:3072 sc1
    v_mfma_f32_16x16x32_bf16 v[68:71], v[116:119], v[80:83], v[68:71]
    v_mfma_f32_16x16x32_bf16 v[72:75], v[120:123], v[80:83], v[72:75]
    v_mfma_f32_16x16x32_bf16 v[76:79], v[124:127], v[80:83], v[76:79]
    s_waitcnt vmcnt(8)
    v_mfma_f32_16x16x32_bf16 v[16:19], v[128:131], v[84:87], v[16:19]
    s_add_u32 s44, s44, 4096
    buffer_load_dwordx4 v[232:235], v244, s[8:11], s44 offen offset:0 sc1
    v_mfma_f32_16x16x32_bf16 v[20:23], v[132:135], v[84:87], v[20:23]
    v_mfma_f32_16x16x32_bf16 v[24:27], v[136:139], v[84:87], v[24:27]
    v_mfma_f32_16x16x32_bf16 v[28:31], v[140:143], v[84:87], v[28:31]
    s_waitcnt vmcnt(8)
    v_mfma_f32_16x16x32_bf16 v[32:35], v[128:131], v[88:91], v[32:35]
    buffer_load_dwordx4 v[236:239], v245, s[8:11], s44 offen offset:0 sc1
    v_mfma_f32_16x16x32_bf16 v[36:39], v[132:135], v[88:91], v[36:39]
    v_mfma_f32_16x16x32_bf16 v[40:43], v[136:139], v[88:91], v[40:43]
    v_mfma_f32_16x16x32_bf16 v[44:47], v[140:143], v[88:91], v[44:47]
    s_waitcnt vmcnt(8)
    v_mfma_f32_16x16x32_bf16 v[48:51], v[128:131], v[92:95], v[48:51]
    buffer_load_dwordx4 v[80:83], v246, s[8:11], s44 offen offset:0 sc1
    v_mfma_f32_16x16x32_bf16 v[52:55], v[132:135], v[92:95], v[52:55]
    v_mfma_f32_16x16x32_bf16 v[56:59], v[136:139], v[92:95], v[56:59]
    v_mfma_f32_16x16x32_bf16 v[60:63], v[140:143], v[92:95], v[60:63]
    s_waitcnt vmcnt(8)
    v_mfma_f32_16x16x32_bf16 v[64:67], v[128:131], v[96:99], v[64:67]
    buffer_load_dwordx4 v[112:115], v247, s[8:11], s44 offen offset:0 sc1
    v_mfma_f32_16x16x32_bf16 v[68:71], v[132:135], v[96:99], v[68:71]
    v_mfma_f32_16x16x32_bf16 v[72:75], v[136:139], v[96:99], v[72:75]
    v_mfma_f32_16x16x32_bf16 v[76:79], v[140:143], v[96:99], v[76:79]
    s_waitcnt vmcnt(8)
    v_readfirstlane_b32 s28, v249
    s_nop 0
    s_cmp_ge_u32 s28, 8
    s_cbranch_scc1 L_kf_p7ok
    s_lshl_b32 s24, s15, 2
    s_add_u32 s24, s24, s12
    s_mul_i32 s24, s24, 256
    s_add_u32 s24, s24, 25427968
    v_mov_b32 v248, s24
    v_mov_b32 v251, 0
    s_mov_b32 s30, 0
    s_mov_b64 exec, 1
L_kf_p7:
    global_atomic_add v249, v248, v251, s[58:59] sc0 sc1
    s_add_u32 s30, s30, 1
    s_waitcnt vmcnt(0)
    v_readfirstlane_b32 s28, v249
    s_nop 0
    s_cmp_ge_u32 s28, 8
    s_cbranch_scc1 L_kf_p7d
    s_cmp_lt_u32 s30, 0x100000
    s_cbranch_scc1 L_kf_p7
L_kf_p7d:
    s_mov_b64 exec, -1
L_kf_p7ok:
    s_waitcnt vmcnt(7)
    v_mfma_f32_16x16x32_bf16 v[16:19], v[144:147], v[100:103], v[16:19]
    buffer_load_dwordx4 v[116:119], v244, s[8:11], s29 offen offset:0 sc1
    v_mfma_f32_16x16x32_bf16 v[20:23], v[148:151], v[100:103], v[20:23]
    v_mfma_f32_16x16x32_bf16 v[24:27], v[152:155], v[100:103], v[24:27]
    v_mfma_f32_16x16x32_bf16 v[28:31], v[156:159], v[100:103], v[28:31]
    s_waitcnt vmcnt(7)
    v_mfma_f32_16x16x32_bf16 v[32:35], v[144:147], v[104:107], v[32:35]
    buffer_load_dwordx4 v[120:123], v245, s[8:11], s29 offen offset:0 sc1
    v_mfma_f32_16x16x32_bf16 v[36:39], v[148:151], v[104:107], v[36:39]
    v_mfma_f32_16x16x32_bf16 v[40:43], v[152:155], v[104:107], v[40:43]
    v_mfma_f32_16x16x32_bf16 v[44:47], v[156:159], v[104:107], v[44:47]
    s_waitcnt vmcnt(7)
    v_mfma_f32_16x16x32_bf16 v[48:51], v[144:147], v[108:111], v[48:51]
    buffer_load_dwordx4 v[124:127], v246, s[8:11], s29 offen offset:0 sc1
    v_mfma_f32_16x16x32_bf16 v[52:55], v[148:151], v[108:111], v[52:55]
    v_mfma_f32_16x16x32_bf16 v[56:59], v[152:155], v[108:111], v[56:59]
    v_mfma_f32_16x16x32_bf16 v[60:63], v[156:159], v[108:111], v[60:63]
    s_waitcnt vmcnt(7)
    v_mfma_f32_16x16x32_bf16 v[64:67], v[144:147], v[224:227], v[64:67]
    buffer_load_dwordx4 v[84:87], v247, s[8:11], s29 offen offset:0 sc1
    v_mfma_f32_16x16x32_bf16 v[68:71], v[148:151], v[224:227], v[68:71]
    v_mfma_f32_16x16x32_bf16 v[72:75], v[152:155], v[224:227], v[72:75]
    v_mfma_f32_16x16x32_bf16 v[76:79], v[156:159], v[224:227], v[76:79]
    s_waitcnt vmcnt(7)
    v_mfma_f32_16x16x32_bf16 v[16:19], v[160:163], v[232:235], v[16:19]
    buffer_load_dwordx4 v[88:91], v244, s[8:11], s29 offen offset:1024 sc1
    v_mfma_f32_16x16x32_bf16 v[20:23], v[164:167], v[232:235], v[20:23]
    v_mfma_f32_16x16x32_bf16 v[24:27], v[168:171], v[232:235], v[24:27]
    v_mfma_f32_16x16x32_bf16 v[28:31], v[172:175], v[232:235], v[28:31]
    s_waitcnt vmcnt(7)
    v_mfma_f32_16x16x32_bf16 v[32:35], v[160:163], v[236:239], v[32:35]
    buffer_load_dwordx4 v[92:95], v245, s[8:11], s29 offen offset:1024 sc1
    v_mfma_f32_16x16x32_bf16 v[36:39], v[164:167], v[236:239], v[36:39]
    v_mfma_f32_16x16x32_bf16 v[40:43], v[168:171], v[236:239], v[40:43]
    v_mfma_f32_16x16x32_bf16 v[44:47], v[172:175], v[236:239], v[44:47]
    s_waitcnt vmcnt(7)
    v_mfma_f32_16x16x32_bf16 v[48:51], v[160:163], v[80:83], v[48:51]
    buffer_load_dwordx4 v[96:99], v246, s[8:11], s29 offen offset:1024 sc1
    v_mfma_f32_16x16x32_bf16 v[52:55], v[164:167], v[80:83], v[52:55]
    v_mfma_f32_16x16x32_bf16 v[56:59], v[168:171], v[80:83], v[56:59]
    v_mfma_f32_16x16x32_bf16 v[60:63], v[172:175], v[80:83], v[60:63]
    s_waitcnt vmcnt(7)
    v_mfma_f32_16x16x32_bf16 v[64:67], v[160:163], v[112:115], v[64:67]
    buffer_load_dwordx4 v[128:131], v247, s[8:11], s29 offen offset:1024 sc1
    v_mfma_f32_16x16x32_bf16 v[68:71], v[164:167], v[112:115], v[68:71]
    v_mfma_f32_16x16x32_bf16 v[72:75], v[168:171], v[112:115], v[72:75]
    v_mfma_f32_16x16x32_bf16 v[76:79], v[172:175], v[112:115], v[76:79]
    s_waitcnt vmcnt(7)
    v_mfma_f32_16x16x32_bf16 v[16:19], v[176:179], v[116:119], v[16:19]
    buffer_load_dwordx4 v[132:135], v244, s[8:11], s29 offen offset:2048 sc1
    v_mfma_f32_16x16x32_bf16 v[20:23], v[180:183], v[116:119], v[20:23]
    v_mfma_f32_16x16x32_bf16 v[24:27], v[184:187], v[116:119], v[24:27]
    v_mfma_f32_16x16x32_bf16 v[28:31], v[188:191], v[116:119], v[28:31]
    s_waitcnt vmcnt(7)
    v_mfma_f32_16x16x32_bf16 v[32:35], v[176:179], v[120:123], v[32:35]
    buffer_load_dwordx4 v[136:139], v245, s[8:11], s29 offen offset:2048 sc1
    v_mfma_f32_16x16x32_bf16 v[36:39], v[180:183], v[120:123], v[36:39]
    v_mfma_f32_16x16x32_bf16 v[40:43], v[184:187], v[120:123], v[40:43]
    v_mfma_f32_16x16x32_bf16 v[44:47], v[188:191], v[120:123], v[44:47]
    s_waitcnt vmcnt(7)
    v_mfma_f32_16x16x32_bf16 v[48:51], v[176:179], v[124:127], v[48:51]
    buffer_load_dwordx4 v[140:143], v246, s[8:11], s29 offen offset:2048 sc1
    v_mfma_f32_16x16x32_bf16 v[52:55], v[180:183], v[124:127], v[52:55]
    v_mfma_f32_16x16x32_bf16 v[56:59], v[184:187], v[124:127], v[56:59]
    v_mfma_f32_16x16x32_bf16 v[60:63], v[188:191], v[124:127], v[60:63]
    s_waitcnt vmcnt(7)
    v_mfma_f32_16x16x32_bf16 v[64:67], v[176:179], v[84:87], v[64:67]
    buffer_load_dwordx4 v[100:103], v247, s[8:11], s29 offen offset:2048 sc1
    v_mfma_f32_16x16x32_bf16 v[68:71], v[180:183], v[84:87], v[68:71]
    v_mfma_f32_16x16x32_bf16 v[72:75], v[184:187], v[84:87], v[72:75]
    v_mfma_f32_16x16x32_bf16 v[76:79], v[188:191], v[84:87], v[76:79]
    s_waitcnt vmcnt(7)
    v_mfma_f32_16x16x32_bf16 v[16:19], v[192:195], v[88:91], v[16:19]
    v_mfma_f32_16x16x32_bf16 v[20:23], v[196:199], v[88:91], v[20:23]
    v_mfma_f32_16x16x32_bf16 v[24:27], v[200:203], v[88:91], v[24:27]
    v_mfma_f32_16x16x32_bf16 v[28:31], v[204:207], v[88:91], v[28:31]
    s_waitcnt vmcnt(6)
    v_mfma_f32_16x16x32_bf16 v[32:35], v[192:195], v[92:95], v[32:35]
    v_mfma_f32_16x16x32_bf16 v[36:39], v[196:199], v[92:95], v[36:39]
    v_mfma_f32_16x16x32_bf16 v[40:43], v[200:203], v[92:95], v[40:43]
    v_mfma_f32_16x16x32_bf16 v[44:47], v[204:207], v[92:95], v[44:47]
    s_waitcnt vmcnt(5)
    v_mfma_f32_16x16x32_bf16 v[48:51], v[192:195], v[96:99], v[48:51]
    v_mfma_f32_16x16x32_bf16 v[52:55], v[196:199], v[96:99], v[52:55]
    v_mfma_f32_16x16x32_bf16 v[56:59], v[200:203], v[96:99], v[56:59]
    v_mfma_f32_16x16x32_bf16 v[60:63], v[204:207], v[96:99], v[60:63]
    s_waitcnt vmcnt(4)
    v_mfma_f32_16x16x32_bf16 v[64:67], v[192:195], v[128:131], v[64:67]
    v_mfma_f32_16x16x32_bf16 v[68:71], v[196:199], v[128:131], v[68:71]
    v_mfma_f32_16x16x32_bf16 v[72:75], v[200:203], v[128:131], v[72:75]
    v_mfma_f32_16x16x32_bf16 v[76:79], v[204:207], v[128:131], v[76:79]
L_ka_w16:
    ds_read_b32 v255, v252 offset:144
    s_waitcnt lgkmcnt(0)
    v_readfirstlane_b32 s63, v255
    s_nop 0
    s_cmp_lt_u32 s63, 4
    s_cbranch_scc1 L_ka_w16
    s_waitcnt vmcnt(2)
    v_mfma_f32_16x16x32_bf16 v[32:35], v[208:211], v[136:139], v[32:35]
    v_mfma_f32_16x16x32_bf16 v[36:39], v[212:215], v[136:139], v[36:39]
    v_mfma_f32_16x16x32_bf16 v[40:43], v[216:219], v[136:139], v[40:43]
    v_mfma_f32_16x16x32_bf16 v[44:47], v[220:223], v[136:139], v[44:47]
    s_waitcnt vmcnt(1)
    v_mfma_f32_16x16x32_bf16 v[48:51], v[208:211], v[140:143], v[48:51]
    v_mfma_f32_16x16x32_bf16 v[52:55], v[212:215], v[140:143], v[52:55]
    v_mfma_f32_16x16x32_bf16 v[56:59], v[216:219], v[140:143], v[56:59]
    v_mfma_f32_16x16x32_bf16 v[60:63], v[220:223], v[140:143], v[60:63]
    s_waitcnt vmcnt(0)
    v_mfma_f32_16x16x32_bf16 v[64:67], v[208:211], v[100:103], v[64:67]
    ds_write_b128 v241, v[32:35] offset:0
    v_mfma_f32_16x16x32_bf16 v[68:71], v[212:215], v[100:103], v[68:71]
    ds_write_b128 v241, v[36:39] offset:1024
    v_mfma_f32_16x16x32_bf16 v[72:75], v[216:219], v[100:103], v[72:75]
    ds_write_b128 v241, v[40:43] offset:2048
    v_mfma_f32_16x16x32_bf16 v[76:79], v[220:223], v[100:103], v[76:79]
    ds_write_b128 v241, v[44:47] offset:3072
    v_mfma_f32_16x16x32_bf16 v[16:19], v[208:211], v[132:135], v[16:19]
    ds_write_b128 v242, v[48:51] offset:4096
    v_mfma_f32_16x16x32_bf16 v[20:23], v[212:215], v[132:135], v[20:23]
    ds_write_b128 v242, v[52:55] offset:5120
    v_mfma_f32_16x16x32_bf16 v[24:27], v[216:219], v[132:135], v[24:27]
    ds_write_b128 v242, v[56:59] offset:6144
    v_mfma_f32_16x16x32_bf16 v[28:31], v[220:223], v[132:135], v[28:31]
    ds_write_b128 v242, v[60:63] offset:7168
    ds_write_b128 v243, v[64:67] offset:8192
    ds_write_b128 v243, v[68:71] offset:9216
    ds_write_b128 v243, v[72:75] offset:10240
    ds_write_b128 v243, v[76:79] offset:11264
    v_lshlrev_b32 v144, 16, v8
    v_and_b32 v145, s36, v8
    v_lshlrev_b32 v146, 16, v9
    v_and_b32 v147, s36, v9
    v_lshlrev_b32 v148, 16, v10
    v_and_b32 v149, s36, v10
    v_lshlrev_b32 v150, 16, v11
    v_and_b32 v151, s36, v11
    v_lshlrev_b32 v152, 16, v12
    v_and_b32 v153, s36, v12
    v_lshlrev_b32 v154, 16, v13
    v_and_b32 v155, s36, v13
    v_lshlrev_b32 v156, 16, v14
    v_and_b32 v157, s36, v14
    v_lshlrev_b32 v158, 16, v15
    v_and_b32 v159, s36, v15
    s_waitcnt lgkmcnt(0)
    s_barrier
    ds_read_b128 v[80:83], v240 offset:0
    ds_read_b128 v[84:87], v240 offset:1024
    ds_read_b128 v[88:91], v240 offset:2048
    ds_read_b128 v[92:95], v240 offset:3072
    ds_read_b128 v[96:99], v240 offset:4096
    ds_read_b128 v[100:103], v240 offset:5120
    ds_read_b128 v[104:107], v240 offset:6144
    ds_read_b128 v[108:111], v240 offset:7168
    ds_read_b128 v[112:115], v240 offset:8192
    ds_read_b128 v[116:119], v240 offset:9216
    ds_read_b128 v[120:123], v240 offset:10240
    ds_read_b128 v[124:127], v240 offset:11264
    ds_read_b128 v[128:131], v6 offset:49152
    ds_read_b128 v[132:135], v6 offset:50176
    ds_read_b128 v[136:139], v6 offset:51200
    ds_read_b128 v[140:143], v6 offset:52224
    s_waitcnt lgkmcnt(15)
    v_pk_add_f32 v[16:17], v[16:17], v[80:81]
    v_pk_add_f32 v[18:19], v[18:19], v[82:83]
    s_waitcnt lgkmcnt(14)
    v_pk_add_f32 v[20:21], v[20:21], v[84:85]
    v_pk_add_f32 v[22:23], v[22:23], v[86:87]
    s_waitcnt lgkmcnt(13)
    v_pk_add_f32 v[24:25], v[24:25], v[88:89]
    v_pk_add_f32 v[26:27], v[26:27], v[90:91]
    s_waitcnt lgkmcnt(12)
    v_pk_add_f32 v[28:29], v[28:29], v[92:93]
    v_pk_add_f32 v[30:31], v[30:31], v[94:95]
    s_waitcnt lgkmcnt(11)
    v_pk_add_f32 v[16:17], v[16:17], v[96:97]
    v_pk_add_f32 v[18:19], v[18:19], v[98:99]
    s_waitcnt lgkmcnt(10)
    v_pk_add_f32 v[20:21], v[20:21], v[100:101]
    v_pk_add_f32 v[22:23], v[22:23], v[102:103]
    s_waitcnt lgkmcnt(9)
    v_pk_add_f32 v[24:25], v[24:25], v[104:105]
    v_pk_add_f32 v[26:27], v[26:27], v[106:107]
    s_waitcnt lgkmcnt(8)
    v_pk_add_f32 v[28:29], v[28:29], v[108:109]
    v_pk_add_f32 v[30:31], v[30:31], v[110:111]
    s_waitcnt lgkmcnt(7)
    v_pk_add_f32 v[16:17], v[16:17], v[112:113]
    v_pk_add_f32 v[18:19], v[18:19], v[114:115]
    s_waitcnt lgkmcnt(6)
    v_pk_add_f32 v[20:21], v[20:21], v[116:117]
    v_pk_add_f32 v[22:23], v[22:23], v[118:119]
    s_waitcnt lgkmcnt(5)
    v_pk_add_f32 v[24:25], v[24:25], v[120:121]
    v_pk_add_f32 v[26:27], v[26:27], v[122:123]
    s_waitcnt lgkmcnt(4)
    v_pk_add_f32 v[28:29], v[28:29], v[124:125]
    v_pk_add_f32 v[30:31], v[30:31], v[126:127]
    s_waitcnt lgkmcnt(3)
    v_pk_add_f32 v[16:17], v[16:17], v[128:129]
    v_pk_add_f32 v[18:19], v[18:19], v[130:131]
    s_waitcnt lgkmcnt(2)
    v_pk_add_f32 v[20:21], v[20:21], v[132:133]
    v_pk_add_f32 v[22:23], v[22:23], v[134:135]
    s_waitcnt lgkmcnt(1)
    v_pk_add_f32 v[24:25], v[24:25], v[136:137]
    v_pk_add_f32 v[26:27], v[26:27], v[138:139]
    s_waitcnt lgkmcnt(0)
    v_pk_add_f32 v[28:29], v[28:29], v[140:141]
    v_pk_add_f32 v[30:31], v[30:31], v[142:143]
    v_cvt_pk_bf16_f32 v33, v16, v20
    v_cvt_pk_bf16_f32 v35, v24, v28
    v_cvt_pk_bf16_f32 v41, v17, v21
    v_cvt_pk_bf16_f32 v43, v25, v29
    v_cvt_pk_bf16_f32 v37, v18, v22
    v_cvt_pk_bf16_f32 v39, v26, v30
    v_cvt_pk_bf16_f32 v45, v19, v23
    v_cvt_pk_bf16_f32 v47, v27, v31
    v_permlane32_swap_b32 v33, v37
    v_permlane32_swap_b32 v35, v39
    v_permlane32_swap_b32 v41, v45
    v_permlane32_swap_b32 v43, v47
    v_lshlrev_b32 v32, 16, v33
    v_and_b32 v33, s36, v33
    v_lshlrev_b32 v34, 16, v35
    v_and_b32 v35, s36, v35
    v_lshlrev_b32 v36, 16, v37
    v_and_b32 v37, s36, v37
    v_lshlrev_b32 v38, 16, v39
    v_and_b32 v39, s36, v39
    v_lshlrev_b32 v40, 16, v41
    v_and_b32 v41, s36, v41
    v_lshlrev_b32 v42, 16, v43
    v_and_b32 v43, s36, v43
    v_lshlrev_b32 v44, 16, v45
    v_and_b32 v45, s36, v45
    v_lshlrev_b32 v46, 16, v47
    v_and_b32 v47, s36, v47
    v_pk_add_f32 v[32:33], v[32:33], v[144:145]
    v_pk_add_f32 v[34:35], v[34:35], v[146:147]
    v_pk_add_f32 v[36:37], v[36:37], v[148:149]
    v_pk_add_f32 v[38:39], v[38:39], v[150:151]
    v_pk_add_f32 v[40:41], v[40:41], v[152:153]
    v_pk_add_f32 v[42:43], v[42:43], v[154:155]
    v_pk_add_f32 v[44:45], v[44:45], v[156:157]
    v_pk_add_f32 v[46:47], v[46:47], v[158:159]
    v_cvt_pk_bf16_f32 v48, v32, v33
    v_cvt_pk_bf16_f32 v52, v40, v41
    v_cvt_pk_bf16_f32 v49, v34, v35
    v_cvt_pk_bf16_f32 v53, v42, v43
    v_cvt_pk_bf16_f32 v50, v36, v37
    v_cvt_pk_bf16_f32 v54, v44, v45
    v_cvt_pk_bf16_f32 v51, v38, v39
    v_cvt_pk_bf16_f32 v55, v46, v47
    v_permlane16_swap_b32 v48, v52
    v_permlane16_swap_b32 v49, v53
    v_permlane16_swap_b32 v50, v54
    v_permlane16_swap_b32 v51, v55
    global_store_dwordx4 v5, v[48:51], s[6:7] sc1
    global_store_dwordx4 v5, v[52:55], s[6:7] offset:64 sc1
L_kf_fin:
L_ka_end:
    s_endpgm
L_kf_retry:
    buffer_load_dwordx4 v[40:43], v11, s[8:11], s41 offen offset:0 sc1
    buffer_load_dwordx4 v[44:47], v11, s[8:11], s41 offen offset:1024 sc1
    s_add_u32 s30, s30, 1
    s_waitcnt vmcnt(0)
    v_add_f32 v40, v40, v44
    v_add_f32 v41, v41, v45
    v_add_f32 v42, v42, v46
    v_add_f32 v43, v43, v47
    s_nop 0
    v_permlane32_swap_b32 v40, v42
    v_permlane32_swap_b32 v41, v43
    v_add_f32 v40, v40, v42
    v_add_f32 v41, v41, v43
    v_mov_b32 v42, v40
    v_mov_b32 v43, v41
    s_nop 0
    v_permlane16_swap_b32 v40, v42
    v_permlane16_swap_b32 v41, v43
    v_add_f32 v40, v40, v42
    v_add_f32 v41, v41, v43
    v_cmp_u_f32 vcc, v41, v41
    s_cmp_lt_u32 s30, 0x4000
    s_nop 3
    s_cbranch_vccz L_kf_statok
    s_cbranch_scc1 L_kf_retry
    s_branch L_kf_statok
.p2align 6
L_ridx:
.short 0, 0, 0, 0, 0, 0, 0, 0, 0, 0, 0, 0, 0, 0, 0, 0
.short 0, 0, 0, 0, 0, 784, 784, 784, 784, 782, 780, 780, 780, 778, 776, 776
.short 776, 774, 772, 772, 772, 770, 768, 768, 768, 766, 764, 764, 764, 762, 760, 760
.short 760, 758, 756, 756, 756, 754, 752, 752, 752, 750, 748, 748, 748, 746, 744, 744
.short 744, 742, 740, 740, 740, 738, 736, 736, 736, 734, 732, 732, 732, 730, 728, 728
.short 728, 726, 724, 724, 724, 722, 720, 720, 720, 718, 716, 716, 716, 714, 712, 712
.short 712, 710, 708, 708, 708, 706, 704, 704, 704, 702, 700, 700, 700, 698, 696, 696
.short 696, 694, 692, 692, 692, 690, 688, 688, 688, 686, 684, 684, 684, 682, 680, 680
.short 680, 678, 676, 676, 676, 674, 672, 672, 672, 670, 668, 668, 668, 666, 664, 664
.short 664, 662, 660, 660, 660, 658, 656, 656, 656, 654, 652, 652, 652, 650, 648, 648
.short 648, 646, 644, 644, 644, 642, 640, 640, 640, 638, 636, 636, 636, 634, 632, 632
.short 632, 630, 628, 628, 628, 626, 624, 624, 624, 622, 620, 620, 620, 618, 616, 616
.short 616, 614, 612, 612, 612, 610, 608, 608, 608, 606, 604, 604, 604, 602, 600, 600
.short 600, 598, 596, 596, 596, 594, 592, 592, 592, 590, 588, 588, 588, 586, 584, 584
.short 584, 582, 580, 580, 580, 578, 576, 576, 576, 574, 572, 572, 572, 570, 568, 568
.short 568, 566, 564, 564, 564, 562, 560, 560, 560, 558, 556, 556, 556, 554, 552, 552
.short 552, 550, 548, 548, 548, 546, 544, 544, 544, 542, 540, 540, 540, 538, 536, 536
.short 536, 534, 532, 532, 532, 530, 528, 528, 526, 524, 522, 520, 518, 516, 514, 512
.short 510, 508, 506, 504, 502, 500, 498, 496, 494, 492, 490, 488, 486, 484, 482, 480
.short 478, 476, 474, 472, 470, 468, 466, 464, 462, 460, 458, 456, 454, 452, 450, 448
.short 446, 444, 442, 440, 438, 436, 434, 432, 430, 428, 426, 424, 422, 420, 418, 416
.short 414, 412, 410, 408, 406, 404, 402, 400, 398, 396, 394, 392, 390, 388, 386, 384
.short 382, 380, 378, 376, 374, 372, 370, 368, 366, 364, 362, 360, 358, 356, 354, 352
.short 350, 348, 346, 344, 342, 340, 338, 336, 334, 332, 330, 328, 326, 324, 322, 320
.short 318, 316, 314, 312, 310, 308, 306, 304, 302, 300, 298, 296, 294, 292, 290, 288
.short 286, 284, 282, 280, 278, 276, 274, 272, 270, 268, 266, 264, 262, 260, 258, 256
.short 254, 252, 250, 248, 246, 244, 242, 240, 238, 236, 234, 232, 230, 228, 226, 224
.short 222, 220, 218, 216, 214, 212, 210, 208, 206, 204, 202, 200, 198, 196, 194, 192
.short 190, 188, 186, 184, 182, 180, 178, 176, 174, 172, 170, 168, 166, 164, 162, 160
.short 158, 156, 154, 152, 150, 148, 146, 144, 142, 140, 138, 136, 134, 132, 130, 128
.short 126, 124, 122, 120, 118, 116, 114, 112, 110, 108, 106, 104, 102, 100, 98, 96
.short 94, 92, 90, 88, 86, 84, 82, 80, 78, 76, 74, 72, 70, 68, 66, 64
.short 62, 60, 58, 56, 54, 52, 50, 48, 46, 44, 42, 40, 38, 36, 34, 32
.short 30, 28, 26, 24, 22, 20, 18, 16, 0, 0, 0, 0, 0, 0, 0, 0
.short 0, 0, 0, 0, 0, 0, 0, 0, 0, 0, 0, 0, 0, 0, 0, 0
.short 0, 0, 0, 0, 0, 0, 0, 0, 0, 0, 0, 0, 0, 0, 0, 0
.short 0, 0, 0, 1040, 1040, 0, 0, 0, 0, 0, 0, 0, 0, 0, 0, 0
.short 0, 0, 0, 0, 0, 0, 0, 0, 0, 0, 0, 0, 0, 0, 0, 0
.short 0, 0, 0, 0, 0, 0, 0, 0, 0, 0, 0, 0, 0, 0, 0, 0
.short 0, 0, 0, 0, 0, 0, 0, 0, 0, 0, 0, 0, 0, 0, 0, 0
.short 0, 0, 0, 0, 0, 0, 0, 0, 0, 0, 0, 0, 0, 0, 0, 0
.short 0, 0, 0, 0, 0, 0, 0, 0, 0, 0, 0, 0, 0, 0, 0, 0
.short 0, 1040, 1038, 1036, 1034, 1032, 1030, 1028, 1026, 1024, 1022, 1020, 1018, 1016, 1014, 1012
.short 1010, 1008, 1006, 1004, 1002, 1000, 998, 996, 994, 992, 990, 988, 986, 984, 982, 980
.short 978, 976, 974, 972, 970, 968, 966, 964, 962, 960, 958, 956, 954, 952, 950, 948
.short 946, 944, 942, 940, 938, 936, 934, 932, 930, 928, 926, 924, 922, 920, 918, 916
.short 914, 912, 910, 908, 906, 904, 902, 900, 898, 896, 894, 892, 890, 888, 886, 884
.short 882, 880, 878, 876, 874, 872, 870, 868, 866, 864, 862, 860, 858, 856, 854, 852
.short 850, 848, 846, 844, 842, 840, 838, 836, 834, 832, 830, 828, 826, 824, 822, 820
.short 818, 816, 814, 812, 810, 808, 806, 804, 802, 800, 798, 796, 794, 792, 790, 788
.short 786, 0, 0, 0, 0, 0, 0, 0, 0, 0, 0, 0, 0, 0, 0, 0
.short 0, 0, 0, 0, 0, 0, 0, 0, 0, 0, 0, 0, 0, 0, 0, 0
.short 0, 0, 0, 0, 0, 0, 0, 0, 0, 0, 0, 0, 0, 0, 0, 0
.short 0, 0, 0, 0, 0, 0, 0, 0, 0, 0, 0, 0, 0, 0, 0, 0
.short 0, 1296, 1294, 1292, 1290, 1288, 1286, 1284, 1282, 1280, 1278, 1276, 1274, 1272, 1270, 1268
.short 1266, 1264, 1262, 1260, 1258, 1256, 1254, 1252, 1250, 1248, 1246, 1244, 1242, 1240, 1238, 1236
.short 1234, 1232, 1230, 1228, 1226, 1224, 1222, 1220, 1218, 1216, 1214, 1212, 1210, 1208, 1206, 1204
.short 1202, 1200, 1198, 1196, 1194, 1192, 1190, 1188, 1186, 1184, 1182, 1180, 1178, 1176, 1174, 1172
.short 1170, 1168, 1166, 1164, 1162, 1160, 1158, 1156, 1154, 1152, 1150, 1148, 1146, 1144, 1142, 1140
.short 1138, 1136, 1134, 1132, 1130, 1128, 1126, 1124, 1122, 1120, 1118, 1116, 1114, 1112, 1110, 1108
.short 1106, 1104, 1102, 1100, 1098, 1096, 1094, 1092, 1090, 1088, 1086, 1084, 1082, 1080, 1078, 1076
.short 1074, 1072, 1070, 1068, 1066, 1064, 1062, 1060, 1058, 1056, 1054, 1052, 1050, 1048, 1046, 1044
.short 1042, 0, 0, 0, 0, 0, 0, 0, 0, 0, 0, 0, 0, 0, 0, 0
.short 0, 0, 0, 0, 0, 0, 0, 0, 0, 0, 0, 0, 0, 0, 0, 0
.short 0, 0, 0, 0, 0, 0, 0, 0, 0, 0, 0, 0, 0, 0, 0, 0
.p2align 6
L_band:
.short 0, 0, 0x3f80, 0x3f80, 0x3f80, 0x3f80, 0x3f80, 0
.short 0, 0, 0, 0x3f80, 0x3f80, 0x3f80, 0x3f80, 0x3f80
.short 0, 0, 0, 0, 0x3f80, 0x3f80, 0x3f80, 0x3f80
.short 0, 0, 0, 0, 0, 0x3f80, 0x3f80, 0x3f80
.short 0, 0, 0, 0, 0, 0, 0x3f80, 0x3f80
.short 0, 0, 0, 0, 0, 0, 0, 0x3f80
.short 0, 0, 0, 0, 0, 0, 0, 0
.short 0, 0, 0, 0, 0, 0, 0, 0
.short 0, 0, 0, 0, 0, 0, 0, 0
.short 0, 0, 0, 0, 0, 0, 0, 0
.short 0, 0, 0, 0, 0, 0, 0, 0
.short 0, 0, 0, 0, 0, 0, 0, 0
.short 0, 0, 0, 0, 0, 0, 0, 0
.short 0, 0, 0, 0, 0, 0, 0, 0
.short 0, 0, 0, 0, 0, 0, 0, 0
.short 0, 0, 0, 0, 0, 0, 0, 0
.short 0, 0, 0, 0, 0, 0, 0, 0
.short 0, 0, 0, 0, 0, 0, 0, 0
.short 0x3f80, 0, 0, 0, 0, 0, 0, 0
.short 0x3f80, 0x3f80, 0, 0, 0, 0, 0, 0
.short 0x3f80, 0x3f80, 0x3f80, 0, 0, 0, 0, 0
.short 0x3f80, 0x3f80, 0x3f80, 0x3f80, 0, 0, 0, 0
.short 0x3f80, 0x3f80, 0x3f80, 0x3f80, 0x3f80, 0, 0, 0
.short 0, 0x3f80, 0x3f80, 0x3f80, 0x3f80, 0x3f80, 0, 0
.short 0, 0, 0x3f80, 0x3f80, 0x3f80, 0x3f80, 0x3f80, 0
.short 0, 0, 0, 0x3f80, 0x3f80, 0x3f80, 0x3f80, 0x3f80
.short 0, 0, 0, 0, 0x3f80, 0x3f80, 0x3f80, 0x3f80
.short 0, 0, 0, 0, 0, 0x3f80, 0x3f80, 0x3f80
.short 0, 0, 0, 0, 0, 0, 0x3f80, 0x3f80
.short 0, 0, 0, 0, 0, 0, 0, 0x3f80
.short 0, 0, 0, 0, 0, 0, 0, 0
.short 0, 0, 0, 0, 0, 0, 0, 0
.short 0, 0, 0, 0, 0, 0, 0, 0
.short 0, 0, 0, 0, 0, 0, 0, 0
.short 0, 0, 0, 0, 0, 0, 0, 0
.short 0, 0, 0, 0, 0, 0, 0, 0
.short 0, 0, 0, 0, 0, 0, 0, 0
.short 0, 0, 0, 0, 0, 0, 0, 0
.short 0, 0, 0, 0, 0, 0, 0, 0
.short 0, 0, 0, 0, 0, 0, 0, 0
.short 0, 0, 0, 0, 0, 0, 0, 0
.short 0, 0, 0, 0, 0, 0, 0, 0
.short 0x3f80, 0, 0, 0, 0, 0, 0, 0
.short 0x3f80, 0x3f80, 0, 0, 0, 0, 0, 0
.short 0x3f80, 0x3f80, 0x3f80, 0, 0, 0, 0, 0
.short 0x3f80, 0x3f80, 0x3f80, 0x3f80, 0, 0, 0, 0
.short 0x3f80, 0x3f80, 0x3f80, 0x3f80, 0x3f80, 0, 0, 0
.short 0, 0x3f80, 0x3f80, 0x3f80, 0x3f80, 0x3f80, 0, 0
.short 0, 0, 0, 0, 0, 0, 0, 0
.short 0, 0, 0, 0, 0, 0, 0, 0
.short 0, 0, 0, 0, 0, 0, 0, 0
.short 0, 0, 0, 0, 0, 0, 0, 0
.short 0, 0, 0, 0, 0, 0, 0, 0
.short 0, 0, 0, 0, 0, 0, 0, 0
.short 0, 0, 0, 0, 0, 0, 0, 0
.short 0, 0, 0, 0, 0, 0, 0, 0
.short 0, 0, 0, 0, 0, 0, 0, 0
.short 0, 0, 0, 0, 0, 0, 0, 0
.short 0, 0, 0, 0, 0, 0, 0, 0
.short 0, 0, 0, 0, 0, 0, 0, 0
.short 0, 0, 0, 0, 0, 0, 0, 0
.short 0, 0, 0, 0, 0, 0, 0, 0
.short 0, 0, 0, 0, 0, 0, 0, 0
.short 0, 0, 0, 0, 0, 0, 0, 0
.short 0, 0, 0, 0x3f80, 0x3f80, 0x3f80, 0, 0
.short 0, 0, 0, 0, 0x3f80, 0x3f80, 0x3f80, 0
.short 0, 0, 0, 0, 0, 0x3f80, 0x3f80, 0x3f80
.short 0, 0, 0, 0, 0, 0, 0x3f80, 0x3f80
.short 0, 0, 0, 0, 0, 0, 0, 0x3f80
.short 0, 0, 0, 0, 0, 0, 0, 0
.short 0, 0, 0, 0, 0, 0, 0, 0
.short 0, 0, 0, 0, 0, 0, 0, 0
.short 0, 0, 0, 0, 0, 0, 0, 0
.short 0, 0, 0, 0, 0, 0, 0, 0
.short 0, 0, 0, 0, 0, 0, 0, 0
.short 0, 0, 0, 0, 0, 0, 0, 0
.short 0, 0, 0, 0, 0, 0, 0, 0
.short 0, 0, 0, 0, 0, 0, 0, 0
.short 0, 0, 0, 0, 0, 0, 0, 0
.short 0, 0, 0, 0, 0, 0, 0, 0
.short 0, 0, 0, 0, 0, 0, 0, 0
.short 0, 0, 0, 0, 0, 0, 0, 0
.short 0, 0, 0, 0, 0, 0, 0, 0
.short 0x3f80, 0, 0, 0, 0, 0, 0, 0
.short 0x3f80, 0x3f80, 0, 0, 0, 0, 0, 0
.short 0x3f80, 0x3f80, 0x3f80, 0, 0, 0, 0, 0
.short 0, 0x3f80, 0x3f80, 0x3f80, 0, 0, 0, 0
.short 0, 0, 0x3f80, 0x3f80, 0x3f80, 0, 0, 0
.short 0, 0, 0, 0x3f80, 0x3f80, 0x3f80, 0, 0
.short 0, 0, 0, 0, 0x3f80, 0x3f80, 0x3f80, 0
.short 0, 0, 0, 0, 0, 0x3f80, 0x3f80, 0x3f80
.short 0, 0, 0, 0, 0, 0, 0x3f80, 0x3f80
.short 0, 0, 0, 0, 0, 0, 0, 0x3f80
.short 0, 0, 0, 0, 0, 0, 0, 0
.short 0, 0, 0, 0, 0, 0, 0, 0
.short 0, 0, 0, 0, 0, 0, 0, 0
.short 0, 0, 0, 0, 0, 0, 0, 0
.short 0, 0, 0, 0, 0, 0, 0, 0
.short 0, 0, 0, 0, 0, 0, 0, 0
.short 0, 0, 0, 0, 0, 0, 0, 0
.short 0, 0, 0, 0, 0, 0, 0, 0
.short 0, 0, 0, 0, 0, 0, 0, 0
.short 0, 0, 0, 0, 0, 0, 0, 0
.short 0, 0, 0, 0, 0, 0, 0, 0
.short 0, 0, 0, 0, 0, 0, 0, 0
.short 0, 0, 0, 0, 0, 0, 0, 0
.short 0, 0, 0, 0, 0, 0, 0, 0
.short 0x3f80, 0, 0, 0, 0, 0, 0, 0
.short 0x3f80, 0x3f80, 0, 0, 0, 0, 0, 0
.short 0x3f80, 0x3f80, 0x3f80, 0, 0, 0, 0, 0
.short 0, 0x3f80, 0x3f80, 0x3f80, 0, 0, 0, 0
.short 0, 0, 0x3f80, 0x3f80, 0x3f80, 0, 0, 0
.short 0, 0, 0, 0, 0, 0, 0, 0
.short 0, 0, 0, 0, 0, 0, 0, 0
.short 0, 0, 0, 0, 0, 0, 0, 0
.short 0, 0, 0, 0, 0, 0, 0, 0
.short 0, 0, 0, 0, 0, 0, 0, 0
.short 0, 0, 0, 0, 0, 0, 0, 0
.short 0, 0, 0, 0, 0, 0, 0, 0
.short 0, 0, 0, 0, 0, 0, 0, 0
.short 0, 0, 0, 0, 0, 0, 0, 0
.short 0, 0, 0, 0, 0, 0, 0, 0
.short 0, 0, 0, 0, 0, 0, 0, 0
.short 0, 0, 0, 0, 0, 0, 0, 0
.short 0, 0, 0, 0, 0, 0, 0, 0
.short 0, 0, 0, 0, 0, 0, 0, 0
.short 0, 0, 0, 0, 0, 0, 0, 0
.short 0, 0, 0, 0, 0, 0, 0, 0
.short 0x3f80, 0x3f80, 0x3f80, 0x3f80, 0x3f80, 0x3f80, 0x3f80, 0x3f80
.short 0, 0x3f80, 0x3f80, 0x3f80, 0x3f80, 0x3f80, 0x3f80, 0x3f80
.short 0, 0, 0x3f80, 0x3f80, 0x3f80, 0x3f80, 0x3f80, 0x3f80
.short 0, 0, 0, 0x3f80, 0x3f80, 0x3f80, 0x3f80, 0x3f80
.short 0, 0, 0, 0, 0x3f80, 0x3f80, 0x3f80, 0x3f80
.short 0, 0, 0, 0, 0, 0x3f80, 0x3f80, 0x3f80
.short 0, 0, 0, 0, 0, 0, 0x3f80, 0x3f80
.short 0, 0, 0, 0, 0, 0, 0, 0x3f80
.short 0, 0, 0, 0, 0, 0, 0, 0
.short 0, 0, 0, 0, 0, 0, 0, 0
.short 0, 0, 0, 0, 0, 0, 0, 0
.short 0, 0, 0, 0, 0, 0, 0, 0
.short 0, 0, 0, 0, 0, 0, 0, 0
.short 0, 0, 0, 0, 0, 0, 0, 0
.short 0, 0, 0, 0, 0, 0, 0, 0
.short 0, 0, 0, 0, 0, 0, 0, 0
.short 0x3f80, 0, 0, 0, 0, 0, 0, 0
.short 0x3f80, 0x3f80, 0, 0, 0, 0, 0, 0
.short 0x3f80, 0x3f80, 0x3f80, 0, 0, 0, 0, 0
.short 0x3f80, 0x3f80, 0x3f80, 0x3f80, 0, 0, 0, 0
.short 0x3f80, 0x3f80, 0x3f80, 0x3f80, 0x3f80, 0, 0, 0
.short 0x3f80, 0x3f80, 0x3f80, 0x3f80, 0x3f80, 0x3f80, 0, 0
.short 0x3f80, 0x3f80, 0x3f80, 0x3f80, 0x3f80, 0x3f80, 0x3f80, 0
.short 0x3f80, 0x3f80, 0x3f80, 0x3f80, 0x3f80, 0x3f80, 0x3f80, 0x3f80
.short 0x3f80, 0x3f80, 0x3f80, 0x3f80, 0x3f80, 0x3f80, 0x3f80, 0x3f80
.short 0, 0x3f80, 0x3f80, 0x3f80, 0x3f80, 0x3f80, 0x3f80, 0x3f80
.short 0, 0, 0x3f80, 0x3f80, 0x3f80, 0x3f80, 0x3f80, 0x3f80
.short 0, 0, 0, 0x3f80, 0x3f80, 0x3f80, 0x3f80, 0x3f80
.short 0, 0, 0, 0, 0x3f80, 0x3f80, 0x3f80, 0x3f80
.short 0, 0, 0, 0, 0, 0x3f80, 0x3f80, 0x3f80
.short 0, 0, 0, 0, 0, 0, 0x3f80, 0x3f80
.short 0, 0, 0, 0, 0, 0, 0, 0x3f80
.short 0, 0, 0, 0, 0, 0, 0, 0
.short 0, 0, 0, 0, 0, 0, 0, 0
.short 0, 0, 0, 0, 0, 0, 0, 0
.short 0, 0, 0, 0, 0, 0, 0, 0
.short 0, 0, 0, 0, 0, 0, 0, 0
.short 0, 0, 0, 0, 0, 0, 0, 0
.short 0, 0, 0, 0, 0, 0, 0, 0
.short 0, 0, 0, 0, 0, 0, 0, 0
.short 0x3f80, 0, 0, 0, 0, 0, 0, 0
.short 0x3f80, 0x3f80, 0, 0, 0, 0, 0, 0
.short 0x3f80, 0x3f80, 0x3f80, 0, 0, 0, 0, 0
.short 0x3f80, 0x3f80, 0x3f80, 0x3f80, 0, 0, 0, 0
.short 0x3f80, 0x3f80, 0x3f80, 0x3f80, 0x3f80, 0, 0, 0
.short 0x3f80, 0x3f80, 0x3f80, 0x3f80, 0x3f80, 0x3f80, 0, 0
.short 0x3f80, 0x3f80, 0x3f80, 0x3f80, 0x3f80, 0x3f80, 0x3f80, 0
.short 0x3f80, 0x3f80, 0x3f80, 0x3f80, 0x3f80, 0x3f80, 0x3f80, 0x3f80
.short 0, 0, 0, 0, 0, 0, 0, 0
.short 0, 0, 0, 0, 0, 0, 0, 0
.short 0, 0, 0, 0, 0, 0, 0, 0
.short 0, 0, 0, 0, 0, 0, 0, 0
.short 0, 0, 0, 0, 0, 0, 0, 0
.short 0, 0, 0, 0, 0, 0, 0, 0
.short 0, 0, 0, 0, 0, 0, 0, 0
.short 0, 0, 0, 0, 0, 0, 0, 0
.short 0, 0, 0, 0, 0, 0, 0, 0
.short 0, 0, 0, 0, 0, 0, 0, 0
.short 0, 0, 0, 0, 0, 0, 0, 0
.short 0, 0, 0, 0, 0, 0, 0, 0
.short 0, 0, 0, 0, 0, 0, 0, 0
.short 0, 0, 0, 0, 0, 0, 0, 0
.short 0, 0, 0, 0, 0, 0, 0, 0
.short 0, 0, 0, 0, 0, 0, 0, 0
.short 0, 0x3f80, 0x3f80, 0x3f80, 0x3f80, 0x3f80, 0x3f80, 0x3f80
.short 0, 0, 0x3f80, 0x3f80, 0x3f80, 0x3f80, 0x3f80, 0x3f80
.short 0, 0, 0, 0x3f80, 0x3f80, 0x3f80, 0x3f80, 0x3f80
.short 0, 0, 0, 0, 0x3f80, 0x3f80, 0x3f80, 0x3f80
.short 0, 0, 0, 0, 0, 0x3f80, 0x3f80, 0x3f80
.short 0, 0, 0, 0, 0, 0, 0x3f80, 0x3f80
.short 0, 0, 0, 0, 0, 0, 0, 0x3f80
.short 0, 0, 0, 0, 0, 0, 0, 0
.short 0, 0, 0, 0, 0, 0, 0, 0
.short 0, 0, 0, 0, 0, 0, 0, 0
.short 0, 0, 0, 0, 0, 0, 0, 0
.short 0, 0, 0, 0, 0, 0, 0, 0
.short 0, 0, 0, 0, 0, 0, 0, 0
.short 0, 0, 0, 0, 0, 0, 0, 0
.short 0, 0, 0, 0, 0, 0, 0, 0
.short 0, 0, 0, 0, 0, 0, 0, 0
.short 0, 0, 0, 0, 0, 0, 0, 0
.short 0x3f80, 0, 0, 0, 0, 0, 0, 0
.short 0x3f80, 0x3f80, 0, 0, 0, 0, 0, 0
.short 0x3f80, 0x3f80, 0x3f80, 0, 0, 0, 0, 0
.short 0x3f80, 0x3f80, 0x3f80, 0x3f80, 0, 0, 0, 0
.short 0x3f80, 0x3f80, 0x3f80, 0x3f80, 0x3f80, 0, 0, 0
.short 0x3f80, 0x3f80, 0x3f80, 0x3f80, 0x3f80, 0x3f80, 0, 0
.short 0x3f80, 0x3f80, 0x3f80, 0x3f80, 0x3f80, 0x3f80, 0x3f80, 0
.short 0, 0x3f80, 0x3f80, 0x3f80, 0x3f80, 0x3f80, 0x3f80, 0x3f80
.short 0, 0, 0x3f80, 0x3f80, 0x3f80, 0x3f80, 0x3f80, 0x3f80
.short 0, 0, 0, 0x3f80, 0x3f80, 0x3f80, 0x3f80, 0x3f80
.short 0, 0, 0, 0, 0x3f80, 0x3f80, 0x3f80, 0x3f80
.short 0, 0, 0, 0, 0, 0x3f80, 0x3f80, 0x3f80
.short 0, 0, 0, 0, 0, 0, 0x3f80, 0x3f80
.short 0, 0, 0, 0, 0, 0, 0, 0x3f80
.short 0, 0, 0, 0, 0, 0, 0, 0
.short 0, 0, 0, 0, 0, 0, 0, 0
.short 0, 0, 0, 0, 0, 0, 0, 0
.short 0, 0, 0, 0, 0, 0, 0, 0
.short 0, 0, 0, 0, 0, 0, 0, 0
.short 0, 0, 0, 0, 0, 0, 0, 0
.short 0, 0, 0, 0, 0, 0, 0, 0
.short 0, 0, 0, 0, 0, 0, 0, 0
.short 0, 0, 0, 0, 0, 0, 0, 0
.short 0, 0, 0, 0, 0, 0, 0, 0
.short 0x3f80, 0, 0, 0, 0, 0, 0, 0
.short 0x3f80, 0x3f80, 0, 0, 0, 0, 0, 0
.short 0x3f80, 0x3f80, 0x3f80, 0, 0, 0, 0, 0
.short 0x3f80, 0x3f80, 0x3f80, 0x3f80, 0, 0, 0, 0
.short 0x3f80, 0x3f80, 0x3f80, 0x3f80, 0x3f80, 0, 0, 0
.short 0x3f80, 0x3f80, 0x3f80, 0x3f80, 0x3f80, 0x3f80, 0, 0
.short 0x3f80, 0x3f80, 0x3f80, 0x3f80, 0x3f80, 0x3f80, 0x3f80, 0
.short 0, 0, 0, 0, 0, 0, 0, 0
.short 0, 0, 0, 0, 0, 0, 0, 0
.short 0, 0, 0, 0, 0, 0, 0, 0
.short 0, 0, 0, 0, 0, 0, 0, 0
.short 0, 0, 0, 0, 0, 0, 0, 0
.short 0, 0, 0, 0, 0, 0, 0, 0
.short 0, 0, 0, 0, 0, 0, 0, 0
.short 0, 0, 0, 0, 0, 0, 0, 0
.short 0, 0, 0, 0, 0, 0, 0, 0
.short 0, 0, 0, 0, 0, 0, 0, 0
.short 0, 0, 0, 0, 0, 0, 0, 0
.short 0, 0, 0, 0, 0, 0, 0, 0
.short 0, 0, 0, 0, 0, 0, 0, 0
.short 0, 0, 0, 0, 0, 0, 0, 0
.short 0, 0, 0, 0, 0, 0, 0, 0
.short 0, 0, 0, 0, 0, 0, 0, 0
L_code_end:
.section .rodata,"a"
.p2align 6
.amdhsa_kernel sequential_preLN__ssm_conv_s4d__glu_gated_swiglu__prompt_kernel
  .amdhsa_next_free_vgpr 256
  .amdhsa_next_free_sgpr 102
  .amdhsa_accum_offset 256
  .amdhsa_group_segment_fixed_size 0
  .amdhsa_kernarg_size 112
  .amdhsa_user_sgpr_count 2
  .amdhsa_user_sgpr_kernarg_segment_ptr 1
  .amdhsa_system_sgpr_workgroup_id_x 1
.end_amdhsa_kernel
.text
```
